```python
import torch

def _softmax(x, axis=-1):
    return torch.softmax(x, dim=axis)
def _gelu(x):
    return torch.nn.functional.gelu(x, approximate="tanh")
def _silu(x):
    return torch.nn.functional.silu(x)
def _sigmoid(x):
    return torch.sigmoid(x)
def _layernorm(x, axis=-1, eps=1e-5):
    m = x.mean(dim=axis, keepdim=True)
    v = x.var(dim=axis, keepdim=True, unbiased=False)
    return (x - m) / torch.sqrt(v + eps)
def _scatter_add(tgt, idx, src, axis=0):
    return tgt.clone().index_add_(axis, idx, src)
def _segment_sum(src, seg, n):
    out = torch.zeros((n,) + src.shape[1:], dtype=src.dtype)
    return out.index_add_(0, seg, src)
def _pad(x, pw):
    flat = tuple(v for pair in reversed(pw) for v in pair)
    return torch.nn.functional.pad(x, flat)

kernel_name = 'concat_heads__sliding_block_cached__gqa_block_cached__decode'

def setup_inputs():

    _w = (lambda a: (lambda t: t.to(torch.bfloat16) if t.is_floating_point() else t)(torch.as_tensor(a)))
    def _A_setup():
        B, Sq, D = 1, 1, 1024
        Hq, Hkv, Sk, Dh = 32, 4, 65536, 128
        assert Hq % Hkv == 0, (Hq, Hkv)
        return {
            "x": _w((lambda *s: torch.randn(*s, dtype=torch.bfloat16) * 0.2)(B, Sq, D)),
            "k_cache": _w((lambda *s: torch.randn(*s, dtype=torch.bfloat16) * 3.2)(B, Hkv, Sk, Dh)),
            "v_cache": _w((lambda *s: torch.randn(*s, dtype=torch.bfloat16) * 1.6)(B, Hkv, Sk, Dh)),
            "wq": _w((lambda *s: torch.randn(*s, dtype=torch.bfloat16) * 3.2)(D, Hq * Dh) * (D ** -0.5)),
            "wo": _w((lambda *s: torch.randn(*s, dtype=torch.bfloat16) * 1.6)(Hq * Dh, D) * ((Hq * Dh) ** -0.5)),
        }
    _A_in = _A_setup()

    def _B_setup():
        B, Sq, D = 1, 1, 1024
        Hq, Hkv, Sk, Dh = 32, 4, 65536, 128
        assert Hq % Hkv == 0, (Hq, Hkv)
        return {
            "x": _w((lambda *s: torch.randn(*s, dtype=torch.bfloat16) * 0.4)(B, Sq, D)),
            "k_cache": _w((lambda *s: torch.randn(*s, dtype=torch.bfloat16) * 3.2)(B, Hkv, Sk, Dh)),
            "v_cache": _w((lambda *s: torch.randn(*s, dtype=torch.bfloat16) * 0.8)(B, Hkv, Sk, Dh)),
            "wq": _w((lambda *s: torch.randn(*s, dtype=torch.bfloat16) * 3.2)(D, Hq * Dh) * (D ** -0.5)),
            "wo": _w((lambda *s: torch.randn(*s, dtype=torch.bfloat16) * 0.8)(Hq * Dh, D) * ((Hq * Dh) ** -0.5)),
        }
    _B_in = _B_setup()

    return {
        "A_x": _A_in["x"],
        "A_k_cache": _A_in["k_cache"],
        "A_v_cache": _A_in["v_cache"],
        "A_wq": _A_in["wq"],
        "A_wo": _A_in["wo"],
        "B_x": _B_in["x"],
        "B_k_cache": _B_in["k_cache"],
        "B_v_cache": _B_in["v_cache"],
        "B_wq": _B_in["wq"],
        "B_wo": _B_in["wo"],
    }

def reference(A_x, A_k_cache, A_v_cache, A_wq, A_wo, B_x, B_k_cache, B_v_cache, B_wq, B_wo):
    def _A_ref(x, k_cache, v_cache, wq, wo):
        B, Sq, D = x.shape
        Hq, Dh = 32, 128
        Hkv, Sk = k_cache.shape[1], k_cache.shape[2]
        W = min(4096, max(256, Sk // 4))
        rep = Hq // Hkv
        q = (lambda x, *d: x.permute(*d))((x @ wq).reshape(B, Sq, Hq, Dh), 0, 2, 1, 3)
        k = (lambda x, n, axis: torch.repeat_interleave(x, n, dim=axis))(k_cache[:, :, Sk - W:, :], rep, axis=1)
        v = (lambda x, n, axis: torch.repeat_interleave(x, n, dim=axis))(v_cache[:, :, Sk - W:, :], rep, axis=1)
        scores = torch.einsum("bhqd,bhkd->bhqk", q, k) * (Dh ** -0.5)
        p = _softmax(scores, axis=-1)
        o = torch.einsum("bhqk,bhkd->bhqd", p, v)
        return (lambda x, *d: x.permute(*d))(o, 0, 2, 1, 3).reshape(B, Sq, Hq * Dh) @ wo

    def _B_ref(x, k_cache, v_cache, wq, wo):
        B, Sq, D = x.shape
        Hq, Dh = 32, 128
        Hkv = k_cache.shape[1]
        rep = Hq // Hkv
        q = (lambda x, *d: x.permute(*d))((x @ wq).reshape(B, Sq, Hq, Dh), 0, 2, 1, 3)
        k = (lambda x, n, axis: torch.repeat_interleave(x, n, dim=axis))(k_cache, rep, axis=1)
        v = (lambda x, n, axis: torch.repeat_interleave(x, n, dim=axis))(v_cache, rep, axis=1)
        scores = torch.einsum("bhqd,bhkd->bhqk", q, k) * (Dh ** -0.5)
        p = _softmax(scores, axis=-1)
        o = torch.einsum("bhqk,bhkd->bhqd", p, v)
        return (lambda x, *d: x.permute(*d))(o, 0, 2, 1, 3).reshape(B, Sq, Hq * Dh) @ wo

    a = _A_ref(A_x, A_k_cache, A_v_cache, A_wq, A_wo)
    b = _B_ref(B_x, B_k_cache, B_v_cache, B_wq, B_wo)
    return torch.concatenate([a, b], axis=-1)
```

```asm
; @launch grid=(256,1,1) block=(256,1,1) lds=157248
.amdgcn_target "amdgcn-amd-amdhsa--gfx950"
.text
.globl concat_heads__sliding_block_cached__gqa_block_cached__decode_kernel
.p2align 8
.type concat_heads__sliding_block_cached__gqa_block_cached__decode_kernel,@function
concat_heads__sliding_block_cached__gqa_block_cached__decode_kernel:
    s_cmp_ge_u32 s2, 256
    s_cbranch_scc1 L_end
    s_lshr_b32 s89, s2, 7
    s_mul_i32 s89, s89, 40
    s_load_dwordx2 s[36:37], s[0:1], s89
    s_add_u32 s90, s89, 24
    s_load_dwordx2 s[32:33], s[0:1], s90
    v_lshrrev_b32 v15, 6, v0
    v_and_b32 v14, 63, v0
    v_readfirstlane_b32 s3, v15
    v_lshrrev_b32 v15, 3, v14
    v_lshlrev_b32 v3, 16, v15
    v_and_b32 v15, 7, v0
    v_lshl_add_u32 v3, v15, 4, v3
    s_mov_b32 s34, 0x800000
    s_mov_b32 s35, 0x20000
    s_bfe_u32 s89, s2, 0x10006
    s_lshl_b32 s89, s89, 9
    s_lshl_b32 s90, s3, 7
    s_add_u32 s89, s89, s90
    s_lshl_b32 s91, s89, 1
    s_lshl_b32 s89, s89, 13
    s_and_b32 s82, s2, 63
    s_lshr_b32 s90, s2, 6
    s_add_u32 s90, s90, s2
    s_and_b32 s90, s90, 3
    s_lshl_b32 s90, s90, 4
    s_bfe_u32 s23, s2, 0x30003
    s_lshl_b32 s23, s23, 1
    s_add_u32 s90, s90, s23
    s_bfe_u32 s23, s2, 0x10002
    s_add_u32 s23, s23, s90
    s_lshl_b32 s90, s23, 7
    s_add_u32 s89, s89, s90
    v_and_b32 v1, 15, v0
    v_lshrrev_b32 v2, 4, v14
    v_and_b32 v15, 1, v0
    v_lshlrev_b32 v15, 4, v15
    v_lshl_add_u32 v4, v2, 5, v15
    s_mov_b32 s38, 2048
    s_mov_b32 s39, 0x20000
    s_waitcnt lgkmcnt(0)
    buffer_load_dwordx4 v[96:99], v3, s[32:35], s89 offen nt
    s_add_u32 s89, s89, 8192
    buffer_load_dwordx4 v[100:103], v3, s[32:35], s89 offen nt
    s_add_u32 s89, s89, 8192
    buffer_load_dwordx4 v[104:107], v3, s[32:35], s89 offen nt
    s_add_u32 s89, s89, 8192
    buffer_load_dwordx4 v[108:111], v3, s[32:35], s89 offen nt
    s_add_u32 s89, s89, 8192
    buffer_load_dwordx4 v[54:57], v4, s[36:39], s91 offen
    buffer_load_dwordx4 v[58:61], v4, s[36:39], s91 offen offset:128
    buffer_load_dwordx4 v[112:115], v3, s[32:35], s89 offen nt
    s_add_u32 s89, s89, 8192
    buffer_load_dwordx4 v[116:119], v3, s[32:35], s89 offen nt
    s_add_u32 s89, s89, 8192
    buffer_load_dwordx4 v[120:123], v3, s[32:35], s89 offen nt
    s_add_u32 s89, s89, 8192
    buffer_load_dwordx4 v[124:127], v3, s[32:35], s89 offen nt
    s_add_u32 s89, s89, 466944
    buffer_load_dwordx4 v[128:131], v3, s[32:35], s89 offen nt
    s_add_u32 s89, s89, 8192
    buffer_load_dwordx4 v[132:135], v3, s[32:35], s89 offen nt
    s_add_u32 s89, s89, 8192
    buffer_load_dwordx4 v[136:139], v3, s[32:35], s89 offen nt
    s_add_u32 s89, s89, 8192
    buffer_load_dwordx4 v[140:143], v3, s[32:35], s89 offen nt
    s_add_u32 s89, s89, 8192
    buffer_load_dwordx4 v[144:147], v3, s[32:35], s89 offen nt
    s_add_u32 s89, s89, 8192
    buffer_load_dwordx4 v[148:151], v3, s[32:35], s89 offen nt
    s_add_u32 s89, s89, 8192
    buffer_load_dwordx4 v[152:155], v3, s[32:35], s89 offen nt
    s_add_u32 s89, s89, 8192
    buffer_load_dwordx4 v[156:159], v3, s[32:35], s89 offen nt
    s_and_b32 s89, s82, 0x31
    s_lshr_b32 s90, s82, 1
    s_sub_u32 s91, s82, 8
    s_cmp_lt_u32 s82, 16
    s_cselect_b32 s90, s90, s91
    s_cmp_eq_u32 s89, 0
    s_cselect_b32 s24, 1, 0
    s_cselect_b32 s89, 8, 48
    s_cselect_b32 s26, s90, s82
    s_load_dwordx2 s[40:41], s[0:1], s89
    s_add_u32 s89, s89, 8
    s_load_dwordx2 s[44:45], s[0:1], s89
    s_load_dwordx2 s[64:65], s[0:1], 96
    s_load_dwordx2 s[48:49], s[0:1], 48
    s_load_dwordx2 s[52:53], s[0:1], 56
    s_load_dwordx2 s[56:57], s[0:1], 32
    s_load_dwordx2 s[60:61], s[0:1], 72
    s_load_dwordx2 s[68:69], s[0:1], 80
    s_mov_b32 s42, 0x4000000
    s_mov_b32 s43, 0x20000
    s_mov_b32 s50, 0x4000000
    s_mov_b32 s51, 0x20000
    s_mov_b32 s46, 0x4000000
    s_mov_b32 s47, 0x20000
    s_mov_b32 s54, 0x4000000
    s_mov_b32 s55, 0x20000
    s_mov_b32 s58, 0x800000
    s_mov_b32 s59, 0x20000
    s_mov_b32 s62, 0x800000
    s_mov_b32 s63, 0x20000
    s_mov_b32 s66, 0x500000
    s_mov_b32 s67, 0x20000
    s_mov_b32 s70, 0x1000
    s_mov_b32 s71, 0x20000
    s_lshr_b32 s81, s2, 6
    s_lshl_b32 s25, s81, 24
    s_mul_i32 s91, s81, 1048576
    s_lshl_b32 s89, s82, 2
    s_add_u32 s89, s89, s3
    s_lshl_b32 s89, s89, 12
    s_add_u32 s84, s89, s91
    s_lshl_b32 s90, s90, 2
    s_add_u32 s90, s90, s3
    s_lshl_b32 s90, s90, 12
    s_add_u32 s91, s91, 0x900000
    s_cmp_eq_u32 s24, 1
    s_cselect_b32 s91, 15728640, s91
    s_mov_b32 s86, 917504
    s_cselect_b32 s86, 0x20000, s86
    s_add_u32 s83, s90, s91
    s_mul_i32 s85, s3, 36864
    s_mov_b32 s76, 0x3ff
    s_mov_b32 s77, 0x05040100
    s_mov_b32 s78, 0x07060302
    s_mov_b32 s79, 0x3db504f3
    s_mov_b32 s80, 0x3fb8aa3b
    s_mov_b32 s96, 0x00ff00ff
    s_mov_b32 s97, 0x00ff00ff
    v_lshlrev_b32 v9, 4, v14
    v_lshlrev_b32 v15, 2, v2
    v_xor_b32 v15, v15, v1
    v_xor_b32 v5, 0, v15
    v_lshlrev_b32 v5, 4, v5
    v_lshl_add_u32 v5, v2, 8, v5
    v_xor_b32 v6, 1, v15
    v_lshlrev_b32 v6, 4, v6
    v_lshl_add_u32 v6, v2, 8, v6
    v_xor_b32 v7, 2, v15
    v_lshlrev_b32 v7, 4, v7
    v_lshl_add_u32 v7, v2, 8, v7
    v_xor_b32 v8, 3, v15
    v_lshlrev_b32 v8, 4, v8
    v_lshl_add_u32 v8, v2, 8, v8
    s_waitcnt lgkmcnt(0)
    s_load_dword s30, s[64:65], 0
    s_and_b32 s89, s23, 15
    s_or_b32 s89, s89, s81
    s_or_b32 s89, s89, s3
    s_cmp_lg_u32 s89, 0
    s_cbranch_scc1 L_noinit
    s_lshl_b32 s89, s23, 4
    v_mov_b32 v15, 0
    s_mov_b64 exec, 1
    buffer_store_dword v15, v15, s[64:67], s89 offen offset:1024 sc1
    s_mov_b64 exec, -1
L_noinit:
    s_waitcnt vmcnt(8)
    s_add_u32 s92, s84, 0
    s_and_b32 s92, s92, 0xffffff
    s_or_b32 s92, s92, s25
    s_add_u32 m0, s85, 0
    s_nop 0
    buffer_load_dwordx4 v5, s[48:51], s92 offen offset:0 nt lds
    buffer_load_dwordx4 v6, s[48:51], s92 offen offset:1024 nt lds
    buffer_load_dwordx4 v7, s[48:51], s92 offen offset:2048 nt lds
    buffer_load_dwordx4 v8, s[48:51], s92 offen offset:3072 nt lds
    v_and_b32 v62, 3, v1
    v_lshlrev_b32 v62, 2, v62
    v_lshrrev_b32 v63, 2, v1
    v_add_u32 v62, v62, v63
    v_lshlrev_b32 v62, 8, v62
    v_add_u32 v62, s85, v62
    v_xor_b32 v15, v2, v1
    v_xor_b32 v10, 0, v15
    v_lshl_add_u32 v10, v10, 4, v62
    v_xor_b32 v11, 4, v15
    v_lshl_add_u32 v11, v11, 4, v62
    v_xor_b32 v12, 8, v15
    v_lshl_add_u32 v12, v12, 4, v62
    v_xor_b32 v13, 12, v15
    v_lshl_add_u32 v13, v13, 4, v62
    v_mov_b32 v50, 0xff800000
    v_mov_b32 v51, 0xff800000
    v_mov_b32 v52, 0
    v_mov_b32 v53, 0
    s_waitcnt lgkmcnt(0)
    s_add_u32 s30, s30, 1
    s_add_u32 s72, s30, 0
    s_and_b32 s72, s72, 0x3ff
    s_add_u32 s73, s30, 341
    s_and_b32 s73, s73, 0x3ff
    s_add_u32 s74, s30, 682
    s_and_b32 s74, s74, 0x3ff
    s_add_u32 s75, s30, 1023
    s_and_b32 s75, s75, 0x3ff
    v_mov_b32 v0, s72
    v_mov_b32 v4, s73
    v_mov_b32 v62, s74
    v_mov_b32 v63, s75
    s_mov_b32 s19, 0x00010001
    s_mov_b32 s14, 0x0f0f0f0f
    s_mov_b32 s15, 0x0f0f0f0f
    s_bfe_i32 s18, s30, 0x10000
    s_xor_b32 s18, s18, 0x9e3779b9
    s_bfe_i32 s17, s30, 0x10001
    s_xor_b32 s17, s17, 0x7f4a7c15
    v_perm_b32 v64, v100, v96, s77
    v_perm_b32 v65, v108, v104, s77
    v_perm_b32 v66, v116, v112, s77
    v_perm_b32 v67, v124, v120, s77
    v_perm_b32 v68, v100, v96, s78
    v_perm_b32 v69, v108, v104, s78
    v_perm_b32 v70, v116, v112, s78
    v_perm_b32 v71, v124, v120, s78
    v_perm_b32 v72, v101, v97, s77
    v_perm_b32 v73, v109, v105, s77
    v_perm_b32 v74, v117, v113, s77
    v_perm_b32 v75, v125, v121, s77
    v_perm_b32 v76, v101, v97, s78
    v_perm_b32 v77, v109, v105, s78
    v_perm_b32 v78, v117, v113, s78
    v_perm_b32 v79, v125, v121, s78
    v_perm_b32 v80, v102, v98, s77
    v_perm_b32 v81, v110, v106, s77
    v_perm_b32 v82, v118, v114, s77
    v_perm_b32 v83, v126, v122, s77
    v_perm_b32 v84, v102, v98, s78
    v_perm_b32 v85, v110, v106, s78
    v_perm_b32 v86, v118, v114, s78
    v_perm_b32 v87, v126, v122, s78
    v_perm_b32 v88, v103, v99, s77
    v_perm_b32 v89, v111, v107, s77
    v_perm_b32 v90, v119, v115, s77
    v_perm_b32 v91, v127, v123, s77
    v_perm_b32 v92, v103, v99, s78
    v_perm_b32 v93, v111, v107, s78
    v_perm_b32 v94, v119, v115, s78
    v_perm_b32 v95, v127, v123, s78
    v_mfma_f32_16x16x32_bf16 v[16:19], v[54:57], v[64:67], 0
    v_mfma_f32_16x16x32_bf16 v[20:23], v[54:57], v[68:71], 0
    v_mfma_f32_16x16x32_bf16 v[24:27], v[54:57], v[72:75], 0
    v_mfma_f32_16x16x32_bf16 v[28:31], v[54:57], v[76:79], 0
    v_mfma_f32_16x16x32_bf16 v[32:35], v[54:57], v[80:83], 0
    v_mfma_f32_16x16x32_bf16 v[36:39], v[54:57], v[84:87], 0
    v_mfma_f32_16x16x32_bf16 v[40:43], v[54:57], v[88:91], 0
    v_mfma_f32_16x16x32_bf16 v[44:47], v[54:57], v[92:95], 0
    s_waitcnt vmcnt(8)
    s_mul_i32 s92, s86, 0
    s_add_u32 s92, s92, s83
    s_and_b32 s92, s92, 0xffffff
    s_or_b32 s92, s92, s25
    s_add_u32 m0, s85, 4096
    s_nop 0
    buffer_load_dwordx4 v5, s[40:43], s92 offen offset:0 nt lds
    buffer_load_dwordx4 v6, s[40:43], s92 offen offset:1024 nt lds
    buffer_load_dwordx4 v7, s[40:43], s92 offen offset:2048 nt lds
    buffer_load_dwordx4 v8, s[40:43], s92 offen offset:3072 nt lds
    s_waitcnt vmcnt(8)
    s_mul_i32 s92, s86, 1
    s_add_u32 s92, s92, s83
    s_and_b32 s92, s92, 0xffffff
    s_or_b32 s92, s92, s25
    s_add_u32 m0, s85, 8192
    s_nop 0
    buffer_load_dwordx4 v5, s[40:43], s92 offen offset:0 nt lds
    buffer_load_dwordx4 v6, s[40:43], s92 offen offset:1024 nt lds
    buffer_load_dwordx4 v7, s[40:43], s92 offen offset:2048 nt lds
    buffer_load_dwordx4 v8, s[40:43], s92 offen offset:3072 nt lds
    v_perm_b32 v64, v132, v128, s77
    v_perm_b32 v65, v140, v136, s77
    v_perm_b32 v66, v148, v144, s77
    v_perm_b32 v67, v156, v152, s77
    v_perm_b32 v68, v132, v128, s78
    v_perm_b32 v69, v140, v136, s78
    v_perm_b32 v70, v148, v144, s78
    v_perm_b32 v71, v156, v152, s78
    v_perm_b32 v72, v133, v129, s77
    v_perm_b32 v73, v141, v137, s77
    v_perm_b32 v74, v149, v145, s77
    v_perm_b32 v75, v157, v153, s77
    v_perm_b32 v76, v133, v129, s78
    v_perm_b32 v77, v141, v137, s78
    v_perm_b32 v78, v149, v145, s78
    v_perm_b32 v79, v157, v153, s78
    v_perm_b32 v80, v134, v130, s77
    v_perm_b32 v81, v142, v138, s77
    v_perm_b32 v82, v150, v146, s77
    v_perm_b32 v83, v158, v154, s77
    v_perm_b32 v84, v134, v130, s78
    v_perm_b32 v85, v142, v138, s78
    v_perm_b32 v86, v150, v146, s78
    v_perm_b32 v87, v158, v154, s78
    v_perm_b32 v88, v135, v131, s77
    v_perm_b32 v89, v143, v139, s77
    v_perm_b32 v90, v151, v147, s77
    v_perm_b32 v91, v159, v155, s77
    v_perm_b32 v92, v135, v131, s78
    v_perm_b32 v93, v143, v139, s78
    v_perm_b32 v94, v151, v147, s78
    v_perm_b32 v95, v159, v155, s78
    v_mfma_f32_16x16x32_bf16 v[16:19], v[58:61], v[64:67], v[16:19]
    v_mfma_f32_16x16x32_bf16 v[20:23], v[58:61], v[68:71], v[20:23]
    v_mfma_f32_16x16x32_bf16 v[24:27], v[58:61], v[72:75], v[24:27]
    v_mfma_f32_16x16x32_bf16 v[28:31], v[58:61], v[76:79], v[28:31]
    v_mfma_f32_16x16x32_bf16 v[32:35], v[58:61], v[80:83], v[32:35]
    v_mfma_f32_16x16x32_bf16 v[36:39], v[58:61], v[84:87], v[36:39]
    v_mfma_f32_16x16x32_bf16 v[40:43], v[58:61], v[88:91], v[40:43]
    v_mfma_f32_16x16x32_bf16 v[44:47], v[58:61], v[92:95], v[44:47]
    s_nop 0
    v_add_f32_dpp v64, v17, v16 row_ror:8 row_mask:0xf bank_mask:0xf
    v_add_f32_dpp v65, v21, v20 row_ror:8 row_mask:0xf bank_mask:0xf
    v_add_f32_dpp v66, v25, v24 row_ror:8 row_mask:0xf bank_mask:0xf
    v_add_f32_dpp v67, v29, v28 row_ror:8 row_mask:0xf bank_mask:0xf
    v_add_f32_dpp v68, v33, v32 row_ror:8 row_mask:0xf bank_mask:0xf
    v_add_f32_dpp v69, v37, v36 row_ror:8 row_mask:0xf bank_mask:0xf
    v_add_f32_dpp v70, v41, v40 row_ror:8 row_mask:0xf bank_mask:0xf
    v_add_f32_dpp v71, v45, v44 row_ror:8 row_mask:0xf bank_mask:0xf
    s_lshl_b32 s89, s3, 8
    s_add_u32 s89, s89, 147456
    v_lshl_add_u32 v15, v14, 5, s89
    s_mov_b64 exec, 0xff
    ds_write_b128 v15, v[64:67]
    ds_write_b128 v15, v[68:71] offset:16
    s_mov_b64 exec, -1
    s_waitcnt lgkmcnt(0)
    s_barrier
    s_cmp_lg_u32 s3, 0
    s_cbranch_scc1 L_qpub_done
    s_mov_b64 exec, 0xffff
    v_add_u32 v80, 147456, v9
    ds_read_b128 v[64:67], v80 offset:0
    ds_read_b128 v[68:71], v80 offset:256
    ds_read_b128 v[72:75], v80 offset:512
    ds_read_b128 v[76:79], v80 offset:768
    s_lshl_b32 s89, s81, 14
    s_lshl_b32 s90, s23, 8
    s_add_u32 s89, s89, s90
    s_add_u32 s89, s89, 4096
    s_waitcnt lgkmcnt(0)
    v_add_f32 v64, v64, v68
    v_add_f32 v72, v72, v76
    v_add_f32 v65, v65, v69
    v_add_f32 v73, v73, v77
    v_add_f32 v66, v66, v70
    v_add_f32 v74, v74, v78
    v_add_f32 v67, v67, v71
    v_add_f32 v75, v75, v79
    v_add_f32 v64, v64, v72
    v_add_f32 v65, v65, v73
    v_add_f32 v66, v66, v74
    v_add_f32 v67, v67, v75
    v_bfi_b32 v68, s76, v0, v64
    v_bfi_b32 v69, s76, v4, v65
    v_bfi_b32 v70, s76, v62, v66
    v_bfi_b32 v71, s76, v63, v67
    s_waitcnt vmcnt(12)
    buffer_store_dwordx4 v[68:71], v9, s[64:67], s89 offen sc1
    s_mov_b64 exec, -1
    s_nop 1
L_qpub_done:
    s_waitcnt vmcnt(8)
    s_mul_i32 s92, s86, 2
    s_add_u32 s92, s92, s83
    s_and_b32 s92, s92, 0xffffff
    s_or_b32 s92, s92, s25
    s_add_u32 m0, s85, 12288
    s_nop 0
    buffer_load_dwordx4 v5, s[40:43], s92 offen offset:0 nt lds
    buffer_load_dwordx4 v6, s[40:43], s92 offen offset:1024 nt lds
    buffer_load_dwordx4 v7, s[40:43], s92 offen offset:2048 nt lds
    buffer_load_dwordx4 v8, s[40:43], s92 offen offset:3072 nt lds
    s_waitcnt vmcnt(8)
    s_mul_i32 s92, s86, 3
    s_add_u32 s92, s92, s83
    s_and_b32 s92, s92, 0xffffff
    s_or_b32 s92, s92, s25
    s_add_u32 m0, s85, 16384
    s_nop 0
    buffer_load_dwordx4 v5, s[40:43], s92 offen offset:0 nt lds
    buffer_load_dwordx4 v6, s[40:43], s92 offen offset:1024 nt lds
    buffer_load_dwordx4 v7, s[40:43], s92 offen offset:2048 nt lds
    buffer_load_dwordx4 v8, s[40:43], s92 offen offset:3072 nt lds
    s_waitcnt vmcnt(8)
    s_mul_i32 s92, s86, 4
    s_add_u32 s92, s92, s83
    s_and_b32 s92, s92, 0xffffff
    s_or_b32 s92, s92, s25
    s_add_u32 m0, s85, 20480
    s_nop 0
    buffer_load_dwordx4 v5, s[40:43], s92 offen offset:0 nt lds
    buffer_load_dwordx4 v6, s[40:43], s92 offen offset:1024 nt lds
    buffer_load_dwordx4 v7, s[40:43], s92 offen offset:2048 nt lds
    buffer_load_dwordx4 v8, s[40:43], s92 offen offset:3072 nt lds
    s_waitcnt vmcnt(8)
    s_mul_i32 s92, s86, 5
    s_add_u32 s92, s92, s83
    s_and_b32 s92, s92, 0xffffff
    s_or_b32 s92, s92, s25
    s_add_u32 m0, s85, 24576
    s_nop 0
    buffer_load_dwordx4 v5, s[40:43], s92 offen offset:0 nt lds
    buffer_load_dwordx4 v6, s[40:43], s92 offen offset:1024 nt lds
    buffer_load_dwordx4 v7, s[40:43], s92 offen offset:2048 nt lds
    buffer_load_dwordx4 v8, s[40:43], s92 offen offset:3072 nt lds
    s_waitcnt vmcnt(8)
    s_mul_i32 s92, s86, 6
    s_add_u32 s92, s92, s83
    s_and_b32 s92, s92, 0xffffff
    s_or_b32 s92, s92, s25
    s_add_u32 m0, s85, 28672
    s_nop 0
    buffer_load_dwordx4 v5, s[40:43], s92 offen offset:0 nt lds
    buffer_load_dwordx4 v6, s[40:43], s92 offen offset:1024 nt lds
    buffer_load_dwordx4 v7, s[40:43], s92 offen offset:2048 nt lds
    buffer_load_dwordx4 v8, s[40:43], s92 offen offset:3072 nt lds
    s_waitcnt vmcnt(8)
    s_mul_i32 s92, s86, 7
    s_add_u32 s92, s92, s83
    s_and_b32 s92, s92, 0xffffff
    s_or_b32 s92, s92, s25
    s_add_u32 m0, s85, 32768
    s_nop 0
    buffer_load_dwordx4 v5, s[40:43], s92 offen offset:0 nt lds
    buffer_load_dwordx4 v6, s[40:43], s92 offen offset:1024 nt lds
    buffer_load_dwordx4 v7, s[40:43], s92 offen offset:2048 nt lds
    buffer_load_dwordx4 v8, s[40:43], s92 offen offset:3072 nt lds
    s_waitcnt vmcnt(8)
    s_mul_i32 s92, s86, 0
    s_add_u32 s92, s92, s83
    s_and_b32 s92, s92, 0xffffff
    s_or_b32 s92, s92, s25
    buffer_load_dwordx4 v[160:163], v9, s[44:47], s92 offen offset:0 nt
    buffer_load_dwordx4 v[164:167], v9, s[44:47], s92 offen offset:1024 nt
    buffer_load_dwordx4 v[168:171], v9, s[44:47], s92 offen offset:2048 nt
    buffer_load_dwordx4 v[172:175], v9, s[44:47], s92 offen offset:3072 nt
    s_waitcnt vmcnt(8)
    s_mul_i32 s92, s86, 1
    s_add_u32 s92, s92, s83
    s_and_b32 s92, s92, 0xffffff
    s_or_b32 s92, s92, s25
    buffer_load_dwordx4 v[176:179], v9, s[44:47], s92 offen offset:0 nt
    buffer_load_dwordx4 v[180:183], v9, s[44:47], s92 offen offset:1024 nt
    buffer_load_dwordx4 v[184:187], v9, s[44:47], s92 offen offset:2048 nt
    buffer_load_dwordx4 v[188:191], v9, s[44:47], s92 offen offset:3072 nt
    s_waitcnt vmcnt(8)
    v_and_b32 v15, 7, v1
    v_lshlrev_b32 v15, 9, v15
    v_lshrrev_b32 v3, 3, v1
    v_lshl_add_u32 v15, v3, 7, v15
    v_lshl_add_u32 v3, v2, 5, v15
    s_lshr_b32 s89, s3, 1
    s_lshl_b32 s89, s89, 15
    s_and_b32 s90, s3, 1
    s_lshl_b32 s90, s90, 8
    s_add_u32 s89, s89, s90
    s_lshl_b32 s90, s81, 12
    s_add_u32 s89, s89, s90
    s_add_u32 s93, s89, 4096
    s_add_u32 s98, s93, 16384
    buffer_load_dwordx4 v[80:83], v3, s[64:67], s93 offen offset:0
    buffer_load_dwordx4 v[84:87], v3, s[64:67], s93 offen offset:16
    buffer_load_dwordx4 v[88:91], v3, s[64:67], s98 offen offset:0
    buffer_load_dwordx4 v[92:95], v3, s[64:67], s98 offen offset:16
    s_waitcnt vmcnt(8)
    s_mul_i32 s92, s86, 2
    s_add_u32 s92, s92, s83
    s_and_b32 s92, s92, 0xffffff
    s_or_b32 s92, s92, s25
    buffer_load_dwordx4 v[192:195], v9, s[44:47], s92 offen offset:0 nt
    buffer_load_dwordx4 v[196:199], v9, s[44:47], s92 offen offset:1024 nt
    buffer_load_dwordx4 v[200:203], v9, s[44:47], s92 offen offset:2048 nt
    buffer_load_dwordx4 v[204:207], v9, s[44:47], s92 offen offset:3072 nt
    s_waitcnt vmcnt(8)
    s_mul_i32 s92, s86, 3
    s_add_u32 s92, s92, s83
    s_and_b32 s92, s92, 0xffffff
    s_or_b32 s92, s92, s25
    buffer_load_dwordx4 v[208:211], v9, s[44:47], s92 offen offset:0 nt
    buffer_load_dwordx4 v[212:215], v9, s[44:47], s92 offen offset:1024 nt
    buffer_load_dwordx4 v[216:219], v9, s[44:47], s92 offen offset:2048 nt
    buffer_load_dwordx4 v[220:223], v9, s[44:47], s92 offen offset:3072 nt
    s_waitcnt vmcnt(8)
    s_mul_i32 s92, s86, 4
    s_add_u32 s92, s92, s83
    s_and_b32 s92, s92, 0xffffff
    s_or_b32 s92, s92, s25
    buffer_load_dwordx4 v[224:227], v9, s[44:47], s92 offen offset:0 nt
    buffer_load_dwordx4 v[228:231], v9, s[44:47], s92 offen offset:1024 nt
    buffer_load_dwordx4 v[232:235], v9, s[44:47], s92 offen offset:2048 nt
    buffer_load_dwordx4 v[236:239], v9, s[44:47], s92 offen offset:3072 nt
    v_xor_b32 v15, s72, v80
    v_bitop3_b32 v15, v15, v81, s73 bitop3:0xf6
    v_bitop3_b32 v15, v15, v82, s74 bitop3:0xf6
    v_bitop3_b32 v15, v15, v83, s75 bitop3:0xf6
    v_bitop3_b32 v15, v15, v84, s72 bitop3:0xf6
    v_bitop3_b32 v15, v15, v85, s73 bitop3:0xf6
    v_bitop3_b32 v15, v15, v86, s74 bitop3:0xf6
    v_bitop3_b32 v15, v15, v87, s75 bitop3:0xf6
    v_bitop3_b32 v15, v15, v88, s72 bitop3:0xf6
    v_bitop3_b32 v15, v15, v89, s73 bitop3:0xf6
    v_bitop3_b32 v15, v15, v90, s74 bitop3:0xf6
    v_bitop3_b32 v15, v15, v91, s75 bitop3:0xf6
    v_bitop3_b32 v15, v15, v92, s72 bitop3:0xf6
    v_bitop3_b32 v15, v15, v93, s73 bitop3:0xf6
    v_bitop3_b32 v15, v15, v94, s74 bitop3:0xf6
    v_bitop3_b32 v15, v15, v95, s75 bitop3:0xf6
    v_and_b32 v15, s76, v15
    v_cmp_ne_u32 vcc, 0, v15
    s_cbranch_vccz L_ok1
    s_mov_b64 s[94:95], exec
    s_mov_b32 s88, 0
L_spin2:
    s_and_b64 exec, exec, vcc
    s_sleep 2
    buffer_load_dwordx4 v[80:83], v3, s[64:67], s93 offen offset:0 sc1
    buffer_load_dwordx4 v[84:87], v3, s[64:67], s93 offen offset:16 sc1
    buffer_load_dwordx4 v[88:91], v3, s[64:67], s98 offen offset:0 sc1
    buffer_load_dwordx4 v[92:95], v3, s[64:67], s98 offen offset:16 sc1
    s_waitcnt vmcnt(0)
    v_xor_b32 v15, s72, v80
    v_bitop3_b32 v15, v15, v81, s73 bitop3:0xf6
    v_bitop3_b32 v15, v15, v82, s74 bitop3:0xf6
    v_bitop3_b32 v15, v15, v83, s75 bitop3:0xf6
    v_bitop3_b32 v15, v15, v84, s72 bitop3:0xf6
    v_bitop3_b32 v15, v15, v85, s73 bitop3:0xf6
    v_bitop3_b32 v15, v15, v86, s74 bitop3:0xf6
    v_bitop3_b32 v15, v15, v87, s75 bitop3:0xf6
    v_bitop3_b32 v15, v15, v88, s72 bitop3:0xf6
    v_bitop3_b32 v15, v15, v89, s73 bitop3:0xf6
    v_bitop3_b32 v15, v15, v90, s74 bitop3:0xf6
    v_bitop3_b32 v15, v15, v91, s75 bitop3:0xf6
    v_bitop3_b32 v15, v15, v92, s72 bitop3:0xf6
    v_bitop3_b32 v15, v15, v93, s73 bitop3:0xf6
    v_bitop3_b32 v15, v15, v94, s74 bitop3:0xf6
    v_bitop3_b32 v15, v15, v95, s75 bitop3:0xf6
    v_and_b32 v15, s76, v15
    v_cmp_ne_u32 vcc, 0, v15
    s_add_u32 s88, s88, 1
    s_cmp_ge_u32 s88, 20000
    s_cbranch_scc1 L_res3
    s_cbranch_vccnz L_spin2
L_res3:
    s_mov_b64 exec, s[94:95]
L_ok1:
    v_add_f32 v80, v80, v88
    v_add_f32 v81, v81, v89
    v_add_f32 v82, v82, v90
    v_add_f32 v83, v83, v91
    v_add_f32 v84, v84, v92
    v_add_f32 v85, v85, v93
    v_add_f32 v86, v86, v94
    v_add_f32 v87, v87, v95
    v_cvt_pk_bf16_f32 v64, v80, v81
    v_cvt_pk_bf16_f32 v65, v82, v83
    v_cvt_pk_bf16_f32 v66, v84, v85
    v_cvt_pk_bf16_f32 v67, v86, v87
    s_lshl_b32 s89, s3, 10
    s_add_u32 s89, s89, 148480
    v_lshlrev_b32 v15, 6, v1
    v_lshl_add_u32 v15, v2, 4, v15
    v_add_u32 v68, s89, v15
    ds_write_b128 v68, v[64:67]
    v_and_b32 v15, 0x1ff, v15
    s_lshl_b32 s89, s24, 11
    s_sub_u32 s89, 150528, s89
    v_add_u32 v69, s89, v15
    v_add_u32 v15, 150528, v15
    s_waitcnt lgkmcnt(0)
    s_barrier
    ds_read_b128 a[64:67], v15 offset:0
    ds_read_b128 a[68:71], v15 offset:512
    ds_read_b128 a[72:75], v15 offset:1024
    ds_read_b128 a[76:79], v15 offset:1536
    ds_read_b128 a[80:83], v69 offset:0
    ds_read_b128 a[84:87], v69 offset:512
    ds_read_b128 a[88:91], v69 offset:1024
    ds_read_b128 a[92:95], v69 offset:1536
    ds_read_b128 a[96:99], v10 offset:0
    ds_read_b128 a[100:103], v11 offset:0
    ds_read_b128 a[104:107], v12 offset:0
    ds_read_b128 a[108:111], v13 offset:0
    s_waitcnt lgkmcnt(3)
    v_mfma_f32_16x16x32_bf16 v[54:57], a[96:99], a[64:67], 0
    s_waitcnt lgkmcnt(2)
    v_mfma_f32_16x16x32_bf16 v[54:57], a[100:103], a[68:71], v[54:57]
    s_waitcnt lgkmcnt(1)
    v_mfma_f32_16x16x32_bf16 v[54:57], a[104:107], a[72:75], v[54:57]
    s_waitcnt lgkmcnt(0)
    v_mfma_f32_16x16x32_bf16 v[54:57], a[108:111], a[76:79], v[54:57]
    s_nop 7
    v_max3_f32 v50, v54, v55, v50
    v_max3_f32 v50, v56, v57, v50
    v_cvt_pk_bf16_f32 v16, v54, v55
    v_cvt_pk_bf16_f32 v17, v56, v57
    v_lshlrev_b32 v54, 16, v16
    v_and_b32 v55, 0xffff0000, v16
    v_lshlrev_b32 v56, 16, v17
    v_and_b32 v57, 0xffff0000, v17
    v_mul_f32 v54, s79, v54
    v_mul_f32 v55, s79, v55
    v_mul_f32 v56, s79, v56
    v_mul_f32 v57, s79, v57
    v_cvt_pk_bf16_f32 v16, v54, v55
    v_cvt_pk_bf16_f32 v17, v56, v57
    ds_read_b128 a[112:115], v10 offset:4096
    ds_read_b128 a[116:119], v11 offset:4096
    ds_read_b128 a[120:123], v12 offset:4096
    ds_read_b128 a[124:127], v13 offset:4096
    s_waitcnt lgkmcnt(3)
    v_mfma_f32_16x16x32_bf16 v[58:61], a[112:115], a[80:83], 0
    s_waitcnt lgkmcnt(2)
    v_mfma_f32_16x16x32_bf16 v[58:61], a[116:119], a[84:87], v[58:61]
    s_waitcnt lgkmcnt(1)
    v_mfma_f32_16x16x32_bf16 v[58:61], a[120:123], a[88:91], v[58:61]
    s_waitcnt lgkmcnt(0)
    v_mfma_f32_16x16x32_bf16 v[58:61], a[124:127], a[92:95], v[58:61]
    s_nop 7
    v_max3_f32 v51, v58, v59, v51
    v_max3_f32 v51, v60, v61, v51
    v_cvt_pk_bf16_f32 v18, v58, v59
    v_cvt_pk_bf16_f32 v19, v60, v61
    v_lshlrev_b32 v58, 16, v18
    v_and_b32 v59, 0xffff0000, v18
    v_lshlrev_b32 v60, 16, v19
    v_and_b32 v61, 0xffff0000, v19
    v_mul_f32 v58, s79, v58
    v_mul_f32 v59, s79, v59
    v_mul_f32 v60, s79, v60
    v_mul_f32 v61, s79, v61
    v_cvt_pk_bf16_f32 v18, v58, v59
    v_cvt_pk_bf16_f32 v19, v60, v61
    ds_read_b128 a[96:99], v10 offset:8192
    ds_read_b128 a[100:103], v11 offset:8192
    ds_read_b128 a[104:107], v12 offset:8192
    ds_read_b128 a[108:111], v13 offset:8192
    s_waitcnt lgkmcnt(3)
    v_mfma_f32_16x16x32_bf16 v[54:57], a[96:99], a[80:83], 0
    s_waitcnt lgkmcnt(2)
    v_mfma_f32_16x16x32_bf16 v[54:57], a[100:103], a[84:87], v[54:57]
    s_waitcnt lgkmcnt(1)
    v_mfma_f32_16x16x32_bf16 v[54:57], a[104:107], a[88:91], v[54:57]
    s_waitcnt lgkmcnt(0)
    v_mfma_f32_16x16x32_bf16 v[54:57], a[108:111], a[92:95], v[54:57]
    s_nop 7
    v_max3_f32 v51, v54, v55, v51
    v_max3_f32 v51, v56, v57, v51
    v_cvt_pk_bf16_f32 v20, v54, v55
    v_cvt_pk_bf16_f32 v21, v56, v57
    v_lshlrev_b32 v54, 16, v20
    v_and_b32 v55, 0xffff0000, v20
    v_lshlrev_b32 v56, 16, v21
    v_and_b32 v57, 0xffff0000, v21
    v_mul_f32 v54, s79, v54
    v_mul_f32 v55, s79, v55
    v_mul_f32 v56, s79, v56
    v_mul_f32 v57, s79, v57
    v_cvt_pk_bf16_f32 v20, v54, v55
    v_cvt_pk_bf16_f32 v21, v56, v57
    s_waitcnt vmcnt(8)
    s_add_u32 s92, s84, 1048576
    s_and_b32 s92, s92, 0xffffff
    s_or_b32 s92, s92, s25
    s_add_u32 m0, s85, 0
    s_nop 0
    buffer_load_dwordx4 v5, s[48:51], s92 offen offset:0 nt lds
    buffer_load_dwordx4 v6, s[48:51], s92 offen offset:1024 nt lds
    buffer_load_dwordx4 v7, s[48:51], s92 offen offset:2048 nt lds
    buffer_load_dwordx4 v8, s[48:51], s92 offen offset:3072 nt lds
    ds_read_b128 a[112:115], v10 offset:12288
    ds_read_b128 a[116:119], v11 offset:12288
    ds_read_b128 a[120:123], v12 offset:12288
    ds_read_b128 a[124:127], v13 offset:12288
    s_waitcnt lgkmcnt(3)
    v_mfma_f32_16x16x32_bf16 v[58:61], a[112:115], a[80:83], 0
    s_waitcnt lgkmcnt(2)
    v_mfma_f32_16x16x32_bf16 v[58:61], a[116:119], a[84:87], v[58:61]
    s_waitcnt lgkmcnt(1)
    v_mfma_f32_16x16x32_bf16 v[58:61], a[120:123], a[88:91], v[58:61]
    s_waitcnt lgkmcnt(0)
    v_mfma_f32_16x16x32_bf16 v[58:61], a[124:127], a[92:95], v[58:61]
    s_nop 7
    v_max3_f32 v51, v58, v59, v51
    v_max3_f32 v51, v60, v61, v51
    v_cvt_pk_bf16_f32 v22, v58, v59
    v_cvt_pk_bf16_f32 v23, v60, v61
    v_lshlrev_b32 v58, 16, v22
    v_and_b32 v59, 0xffff0000, v22
    v_lshlrev_b32 v60, 16, v23
    v_and_b32 v61, 0xffff0000, v23
    v_mul_f32 v58, s79, v58
    v_mul_f32 v59, s79, v59
    v_mul_f32 v60, s79, v60
    v_mul_f32 v61, s79, v61
    v_cvt_pk_bf16_f32 v22, v58, v59
    v_cvt_pk_bf16_f32 v23, v60, v61
    ds_read_b128 a[96:99], v10 offset:16384
    ds_read_b128 a[100:103], v11 offset:16384
    ds_read_b128 a[104:107], v12 offset:16384
    ds_read_b128 a[108:111], v13 offset:16384
    s_waitcnt lgkmcnt(3)
    v_mfma_f32_16x16x32_bf16 v[54:57], a[96:99], a[80:83], 0
    s_waitcnt lgkmcnt(2)
    v_mfma_f32_16x16x32_bf16 v[54:57], a[100:103], a[84:87], v[54:57]
    s_waitcnt lgkmcnt(1)
    v_mfma_f32_16x16x32_bf16 v[54:57], a[104:107], a[88:91], v[54:57]
    s_waitcnt lgkmcnt(0)
    v_mfma_f32_16x16x32_bf16 v[54:57], a[108:111], a[92:95], v[54:57]
    s_nop 7
    v_max3_f32 v51, v54, v55, v51
    v_max3_f32 v51, v56, v57, v51
    v_cvt_pk_bf16_f32 v24, v54, v55
    v_cvt_pk_bf16_f32 v25, v56, v57
    v_lshlrev_b32 v54, 16, v24
    v_and_b32 v55, 0xffff0000, v24
    v_lshlrev_b32 v56, 16, v25
    v_and_b32 v57, 0xffff0000, v25
    v_mul_f32 v54, s79, v54
    v_mul_f32 v55, s79, v55
    v_mul_f32 v56, s79, v56
    v_mul_f32 v57, s79, v57
    v_cvt_pk_bf16_f32 v24, v54, v55
    v_cvt_pk_bf16_f32 v25, v56, v57
    ds_read_b128 a[112:115], v10 offset:20480
    ds_read_b128 a[116:119], v11 offset:20480
    ds_read_b128 a[120:123], v12 offset:20480
    ds_read_b128 a[124:127], v13 offset:20480
    s_waitcnt lgkmcnt(3)
    v_mfma_f32_16x16x32_bf16 v[58:61], a[112:115], a[80:83], 0
    s_waitcnt lgkmcnt(2)
    v_mfma_f32_16x16x32_bf16 v[58:61], a[116:119], a[84:87], v[58:61]
    s_waitcnt lgkmcnt(1)
    v_mfma_f32_16x16x32_bf16 v[58:61], a[120:123], a[88:91], v[58:61]
    s_waitcnt lgkmcnt(0)
    v_mfma_f32_16x16x32_bf16 v[58:61], a[124:127], a[92:95], v[58:61]
    s_nop 7
    v_max3_f32 v51, v58, v59, v51
    v_max3_f32 v51, v60, v61, v51
    v_cvt_pk_bf16_f32 v26, v58, v59
    v_cvt_pk_bf16_f32 v27, v60, v61
    v_lshlrev_b32 v58, 16, v26
    v_and_b32 v59, 0xffff0000, v26
    v_lshlrev_b32 v60, 16, v27
    v_and_b32 v61, 0xffff0000, v27
    v_mul_f32 v58, s79, v58
    v_mul_f32 v59, s79, v59
    v_mul_f32 v60, s79, v60
    v_mul_f32 v61, s79, v61
    v_cvt_pk_bf16_f32 v26, v58, v59
    v_cvt_pk_bf16_f32 v27, v60, v61
    ds_read_b128 a[96:99], v10 offset:24576
    ds_read_b128 a[100:103], v11 offset:24576
    ds_read_b128 a[104:107], v12 offset:24576
    ds_read_b128 a[108:111], v13 offset:24576
    s_waitcnt lgkmcnt(3)
    v_mfma_f32_16x16x32_bf16 v[54:57], a[96:99], a[80:83], 0
    s_waitcnt lgkmcnt(2)
    v_mfma_f32_16x16x32_bf16 v[54:57], a[100:103], a[84:87], v[54:57]
    s_waitcnt lgkmcnt(1)
    v_mfma_f32_16x16x32_bf16 v[54:57], a[104:107], a[88:91], v[54:57]
    s_waitcnt lgkmcnt(0)
    v_mfma_f32_16x16x32_bf16 v[54:57], a[108:111], a[92:95], v[54:57]
    s_nop 7
    v_max3_f32 v51, v54, v55, v51
    v_max3_f32 v51, v56, v57, v51
    v_cvt_pk_bf16_f32 v28, v54, v55
    v_cvt_pk_bf16_f32 v29, v56, v57
    v_lshlrev_b32 v54, 16, v28
    v_and_b32 v55, 0xffff0000, v28
    v_lshlrev_b32 v56, 16, v29
    v_and_b32 v57, 0xffff0000, v29
    v_mul_f32 v54, s79, v54
    v_mul_f32 v55, s79, v55
    v_mul_f32 v56, s79, v56
    v_mul_f32 v57, s79, v57
    v_cvt_pk_bf16_f32 v28, v54, v55
    v_cvt_pk_bf16_f32 v29, v56, v57
    s_waitcnt vmcnt(8)
    s_add_u32 s92, s84, 2097152
    s_and_b32 s92, s92, 0xffffff
    s_or_b32 s92, s92, s25
    s_add_u32 m0, s85, 4096
    s_nop 0
    buffer_load_dwordx4 v5, s[48:51], s92 offen offset:0 nt lds
    buffer_load_dwordx4 v6, s[48:51], s92 offen offset:1024 nt lds
    buffer_load_dwordx4 v7, s[48:51], s92 offen offset:2048 nt lds
    buffer_load_dwordx4 v8, s[48:51], s92 offen offset:3072 nt lds
    ds_read_b128 a[112:115], v10 offset:28672
    ds_read_b128 a[116:119], v11 offset:28672
    ds_read_b128 a[120:123], v12 offset:28672
    ds_read_b128 a[124:127], v13 offset:28672
    s_waitcnt lgkmcnt(3)
    v_mfma_f32_16x16x32_bf16 v[58:61], a[112:115], a[80:83], 0
    s_waitcnt lgkmcnt(2)
    v_mfma_f32_16x16x32_bf16 v[58:61], a[116:119], a[84:87], v[58:61]
    s_waitcnt lgkmcnt(1)
    v_mfma_f32_16x16x32_bf16 v[58:61], a[120:123], a[88:91], v[58:61]
    s_waitcnt lgkmcnt(0)
    v_mfma_f32_16x16x32_bf16 v[58:61], a[124:127], a[92:95], v[58:61]
    s_nop 7
    v_max3_f32 v51, v58, v59, v51
    v_max3_f32 v51, v60, v61, v51
    v_cvt_pk_bf16_f32 v30, v58, v59
    v_cvt_pk_bf16_f32 v31, v60, v61
    v_lshlrev_b32 v58, 16, v30
    v_and_b32 v59, 0xffff0000, v30
    v_lshlrev_b32 v60, 16, v31
    v_and_b32 v61, 0xffff0000, v31
    v_mul_f32 v58, s79, v58
    v_mul_f32 v59, s79, v59
    v_mul_f32 v60, s79, v60
    v_mul_f32 v61, s79, v61
    v_cvt_pk_bf16_f32 v30, v58, v59
    v_cvt_pk_bf16_f32 v31, v60, v61
    ds_read_b128 a[96:99], v10 offset:32768
    ds_read_b128 a[100:103], v11 offset:32768
    ds_read_b128 a[104:107], v12 offset:32768
    ds_read_b128 a[108:111], v13 offset:32768
    s_waitcnt lgkmcnt(3)
    v_mfma_f32_16x16x32_bf16 v[54:57], a[96:99], a[80:83], 0
    s_waitcnt lgkmcnt(2)
    v_mfma_f32_16x16x32_bf16 v[54:57], a[100:103], a[84:87], v[54:57]
    s_waitcnt lgkmcnt(1)
    v_mfma_f32_16x16x32_bf16 v[54:57], a[104:107], a[88:91], v[54:57]
    s_waitcnt lgkmcnt(0)
    v_mfma_f32_16x16x32_bf16 v[54:57], a[108:111], a[92:95], v[54:57]
    s_nop 7
    v_max3_f32 v51, v54, v55, v51
    v_max3_f32 v51, v56, v57, v51
    v_cvt_pk_bf16_f32 v32, v54, v55
    v_cvt_pk_bf16_f32 v33, v56, v57
    v_lshlrev_b32 v54, 16, v32
    v_and_b32 v55, 0xffff0000, v32
    v_lshlrev_b32 v56, 16, v33
    v_and_b32 v57, 0xffff0000, v33
    v_mul_f32 v54, s79, v54
    v_mul_f32 v55, s79, v55
    v_mul_f32 v56, s79, v56
    v_mul_f32 v57, s79, v57
    v_cvt_pk_bf16_f32 v32, v54, v55
    v_cvt_pk_bf16_f32 v33, v56, v57
    s_waitcnt vmcnt(8)
    s_add_u32 s92, s84, 3145728
    s_and_b32 s92, s92, 0xffffff
    s_or_b32 s92, s92, s25
    s_add_u32 m0, s85, 8192
    s_nop 0
    buffer_load_dwordx4 v5, s[48:51], s92 offen offset:0 nt lds
    buffer_load_dwordx4 v6, s[48:51], s92 offen offset:1024 nt lds
    buffer_load_dwordx4 v7, s[48:51], s92 offen offset:2048 nt lds
    buffer_load_dwordx4 v8, s[48:51], s92 offen offset:3072 nt lds
    s_waitcnt vmcnt(8)
    s_add_u32 s92, s84, 4194304
    s_and_b32 s92, s92, 0xffffff
    s_or_b32 s92, s92, s25
    s_add_u32 m0, s85, 12288
    s_nop 0
    buffer_load_dwordx4 v5, s[48:51], s92 offen offset:0 nt lds
    buffer_load_dwordx4 v6, s[48:51], s92 offen offset:1024 nt lds
    buffer_load_dwordx4 v7, s[48:51], s92 offen offset:2048 nt lds
    buffer_load_dwordx4 v8, s[48:51], s92 offen offset:3072 nt lds
    ds_read_b128 a[112:115], v10 offset:0
    ds_read_b128 a[116:119], v11 offset:0
    ds_read_b128 a[120:123], v12 offset:0
    ds_read_b128 a[124:127], v13 offset:0
    s_waitcnt lgkmcnt(3)
    v_mfma_f32_16x16x32_bf16 v[58:61], a[112:115], a[64:67], 0
    s_waitcnt lgkmcnt(2)
    v_mfma_f32_16x16x32_bf16 v[58:61], a[116:119], a[68:71], v[58:61]
    s_waitcnt lgkmcnt(1)
    v_mfma_f32_16x16x32_bf16 v[58:61], a[120:123], a[72:75], v[58:61]
    s_waitcnt lgkmcnt(0)
    v_mfma_f32_16x16x32_bf16 v[58:61], a[124:127], a[76:79], v[58:61]
    s_nop 7
    v_max3_f32 v50, v58, v59, v50
    v_max3_f32 v50, v60, v61, v50
    v_cvt_pk_bf16_f32 v34, v58, v59
    v_cvt_pk_bf16_f32 v35, v60, v61
    v_lshlrev_b32 v58, 16, v34
    v_and_b32 v59, 0xffff0000, v34
    v_lshlrev_b32 v60, 16, v35
    v_and_b32 v61, 0xffff0000, v35
    v_mul_f32 v58, s79, v58
    v_mul_f32 v59, s79, v59
    v_mul_f32 v60, s79, v60
    v_mul_f32 v61, s79, v61
    v_cvt_pk_bf16_f32 v34, v58, v59
    v_cvt_pk_bf16_f32 v35, v60, v61
    s_waitcnt vmcnt(8)
    s_add_u32 s92, s84, 5242880
    s_and_b32 s92, s92, 0xffffff
    s_or_b32 s92, s92, s25
    s_add_u32 m0, s85, 16384
    s_nop 0
    buffer_load_dwordx4 v5, s[48:51], s92 offen offset:0 nt lds
    buffer_load_dwordx4 v6, s[48:51], s92 offen offset:1024 nt lds
    buffer_load_dwordx4 v7, s[48:51], s92 offen offset:2048 nt lds
    buffer_load_dwordx4 v8, s[48:51], s92 offen offset:3072 nt lds
    ds_read_b128 a[96:99], v10 offset:4096
    ds_read_b128 a[100:103], v11 offset:4096
    ds_read_b128 a[104:107], v12 offset:4096
    ds_read_b128 a[108:111], v13 offset:4096
    s_waitcnt lgkmcnt(3)
    v_mfma_f32_16x16x32_bf16 v[54:57], a[96:99], a[64:67], 0
    s_waitcnt lgkmcnt(2)
    v_mfma_f32_16x16x32_bf16 v[54:57], a[100:103], a[68:71], v[54:57]
    s_waitcnt lgkmcnt(1)
    v_mfma_f32_16x16x32_bf16 v[54:57], a[104:107], a[72:75], v[54:57]
    s_waitcnt lgkmcnt(0)
    v_mfma_f32_16x16x32_bf16 v[54:57], a[108:111], a[76:79], v[54:57]
    s_nop 7
    v_max3_f32 v50, v54, v55, v50
    v_max3_f32 v50, v56, v57, v50
    v_cvt_pk_bf16_f32 v36, v54, v55
    v_cvt_pk_bf16_f32 v37, v56, v57
    v_lshlrev_b32 v54, 16, v36
    v_and_b32 v55, 0xffff0000, v36
    v_lshlrev_b32 v56, 16, v37
    v_and_b32 v57, 0xffff0000, v37
    v_mul_f32 v54, s79, v54
    v_mul_f32 v55, s79, v55
    v_mul_f32 v56, s79, v56
    v_mul_f32 v57, s79, v57
    v_cvt_pk_bf16_f32 v36, v54, v55
    v_cvt_pk_bf16_f32 v37, v56, v57
    s_waitcnt vmcnt(8)
    s_add_u32 s92, s84, 6291456
    s_and_b32 s92, s92, 0xffffff
    s_or_b32 s92, s92, s25
    s_add_u32 m0, s85, 20480
    s_nop 0
    buffer_load_dwordx4 v5, s[48:51], s92 offen offset:0 nt lds
    buffer_load_dwordx4 v6, s[48:51], s92 offen offset:1024 nt lds
    buffer_load_dwordx4 v7, s[48:51], s92 offen offset:2048 nt lds
    buffer_load_dwordx4 v8, s[48:51], s92 offen offset:3072 nt lds
    ds_read_b128 a[112:115], v10 offset:8192
    ds_read_b128 a[116:119], v11 offset:8192
    ds_read_b128 a[120:123], v12 offset:8192
    ds_read_b128 a[124:127], v13 offset:8192
    s_waitcnt lgkmcnt(3)
    v_mfma_f32_16x16x32_bf16 v[58:61], a[112:115], a[64:67], 0
    s_waitcnt lgkmcnt(2)
    v_mfma_f32_16x16x32_bf16 v[58:61], a[116:119], a[68:71], v[58:61]
    s_waitcnt lgkmcnt(1)
    v_mfma_f32_16x16x32_bf16 v[58:61], a[120:123], a[72:75], v[58:61]
    s_waitcnt lgkmcnt(0)
    v_mfma_f32_16x16x32_bf16 v[58:61], a[124:127], a[76:79], v[58:61]
    s_nop 7
    v_max3_f32 v50, v58, v59, v50
    v_max3_f32 v50, v60, v61, v50
    v_cvt_pk_bf16_f32 v38, v58, v59
    v_cvt_pk_bf16_f32 v39, v60, v61
    v_lshlrev_b32 v58, 16, v38
    v_and_b32 v59, 0xffff0000, v38
    v_lshlrev_b32 v60, 16, v39
    v_and_b32 v61, 0xffff0000, v39
    v_mul_f32 v58, s79, v58
    v_mul_f32 v59, s79, v59
    v_mul_f32 v60, s79, v60
    v_mul_f32 v61, s79, v61
    v_cvt_pk_bf16_f32 v38, v58, v59
    v_cvt_pk_bf16_f32 v39, v60, v61
    s_waitcnt vmcnt(8)
    s_add_u32 s92, s84, 7340032
    s_and_b32 s92, s92, 0xffffff
    s_or_b32 s92, s92, s25
    s_add_u32 m0, s85, 24576
    s_nop 0
    buffer_load_dwordx4 v5, s[48:51], s92 offen offset:0 nt lds
    buffer_load_dwordx4 v6, s[48:51], s92 offen offset:1024 nt lds
    buffer_load_dwordx4 v7, s[48:51], s92 offen offset:2048 nt lds
    buffer_load_dwordx4 v8, s[48:51], s92 offen offset:3072 nt lds
    ds_read_b128 a[96:99], v10 offset:12288
    ds_read_b128 a[100:103], v11 offset:12288
    ds_read_b128 a[104:107], v12 offset:12288
    ds_read_b128 a[108:111], v13 offset:12288
    s_waitcnt lgkmcnt(3)
    v_mfma_f32_16x16x32_bf16 v[54:57], a[96:99], a[64:67], 0
    s_waitcnt lgkmcnt(2)
    v_mfma_f32_16x16x32_bf16 v[54:57], a[100:103], a[68:71], v[54:57]
    s_waitcnt lgkmcnt(1)
    v_mfma_f32_16x16x32_bf16 v[54:57], a[104:107], a[72:75], v[54:57]
    s_waitcnt lgkmcnt(0)
    v_mfma_f32_16x16x32_bf16 v[54:57], a[108:111], a[76:79], v[54:57]
    s_nop 7
    v_max3_f32 v50, v54, v55, v50
    v_max3_f32 v50, v56, v57, v50
    v_cvt_pk_bf16_f32 v40, v54, v55
    v_cvt_pk_bf16_f32 v41, v56, v57
    v_lshlrev_b32 v54, 16, v40
    v_and_b32 v55, 0xffff0000, v40
    v_lshlrev_b32 v56, 16, v41
    v_and_b32 v57, 0xffff0000, v41
    v_mul_f32 v54, s79, v54
    v_mul_f32 v55, s79, v55
    v_mul_f32 v56, s79, v56
    v_mul_f32 v57, s79, v57
    v_cvt_pk_bf16_f32 v40, v54, v55
    v_cvt_pk_bf16_f32 v41, v56, v57
    s_waitcnt vmcnt(8)
    s_add_u32 s92, s84, 8388608
    s_and_b32 s92, s92, 0xffffff
    s_or_b32 s92, s92, s25
    s_add_u32 m0, s85, 28672
    s_nop 0
    buffer_load_dwordx4 v5, s[48:51], s92 offen offset:0 nt lds
    buffer_load_dwordx4 v6, s[48:51], s92 offen offset:1024 nt lds
    buffer_load_dwordx4 v7, s[48:51], s92 offen offset:2048 nt lds
    buffer_load_dwordx4 v8, s[48:51], s92 offen offset:3072 nt lds
    ds_read_b128 a[112:115], v10 offset:16384
    ds_read_b128 a[116:119], v11 offset:16384
    ds_read_b128 a[120:123], v12 offset:16384
    ds_read_b128 a[124:127], v13 offset:16384
    s_waitcnt lgkmcnt(3)
    v_mfma_f32_16x16x32_bf16 v[58:61], a[112:115], a[64:67], 0
    s_waitcnt lgkmcnt(2)
    v_mfma_f32_16x16x32_bf16 v[58:61], a[116:119], a[68:71], v[58:61]
    s_waitcnt lgkmcnt(1)
    v_mfma_f32_16x16x32_bf16 v[58:61], a[120:123], a[72:75], v[58:61]
    s_waitcnt lgkmcnt(0)
    v_mfma_f32_16x16x32_bf16 v[58:61], a[124:127], a[76:79], v[58:61]
    s_nop 7
    v_max3_f32 v50, v58, v59, v50
    v_max3_f32 v50, v60, v61, v50
    v_cvt_pk_bf16_f32 v42, v58, v59
    v_cvt_pk_bf16_f32 v43, v60, v61
    v_lshlrev_b32 v58, 16, v42
    v_and_b32 v59, 0xffff0000, v42
    v_lshlrev_b32 v60, 16, v43
    v_and_b32 v61, 0xffff0000, v43
    v_mul_f32 v58, s79, v58
    v_mul_f32 v59, s79, v59
    v_mul_f32 v60, s79, v60
    v_mul_f32 v61, s79, v61
    v_cvt_pk_bf16_f32 v42, v58, v59
    v_cvt_pk_bf16_f32 v43, v60, v61
    s_waitcnt vmcnt(8)
    s_mul_i32 s92, s86, 5
    s_add_u32 s92, s92, s83
    s_and_b32 s92, s92, 0xffffff
    s_or_b32 s92, s92, s25
    buffer_load_dwordx4 v[240:243], v9, s[44:47], s92 offen offset:0 nt
    buffer_load_dwordx4 v[244:247], v9, s[44:47], s92 offen offset:1024 nt
    buffer_load_dwordx4 v[248:251], v9, s[44:47], s92 offen offset:2048 nt
    buffer_load_dwordx4 v[252:255], v9, s[44:47], s92 offen offset:3072 nt
    ds_read_b128 a[96:99], v10 offset:20480
    ds_read_b128 a[100:103], v11 offset:20480
    ds_read_b128 a[104:107], v12 offset:20480
    ds_read_b128 a[108:111], v13 offset:20480
    s_waitcnt lgkmcnt(3)
    v_mfma_f32_16x16x32_bf16 v[54:57], a[96:99], a[64:67], 0
    s_waitcnt lgkmcnt(2)
    v_mfma_f32_16x16x32_bf16 v[54:57], a[100:103], a[68:71], v[54:57]
    s_waitcnt lgkmcnt(1)
    v_mfma_f32_16x16x32_bf16 v[54:57], a[104:107], a[72:75], v[54:57]
    s_waitcnt lgkmcnt(0)
    v_mfma_f32_16x16x32_bf16 v[54:57], a[108:111], a[76:79], v[54:57]
    s_nop 7
    v_max3_f32 v50, v54, v55, v50
    v_max3_f32 v50, v56, v57, v50
    v_cvt_pk_bf16_f32 v44, v54, v55
    v_cvt_pk_bf16_f32 v45, v56, v57
    v_lshlrev_b32 v54, 16, v44
    v_and_b32 v55, 0xffff0000, v44
    v_lshlrev_b32 v56, 16, v45
    v_and_b32 v57, 0xffff0000, v45
    v_mul_f32 v54, s79, v54
    v_mul_f32 v55, s79, v55
    v_mul_f32 v56, s79, v56
    v_mul_f32 v57, s79, v57
    v_cvt_pk_bf16_f32 v44, v54, v55
    v_cvt_pk_bf16_f32 v45, v56, v57
    s_waitcnt vmcnt(8)
    s_mul_i32 s92, s86, 6
    s_add_u32 s92, s92, s83
    s_and_b32 s92, s92, 0xffffff
    s_or_b32 s92, s92, s25
    buffer_load_dwordx4 v[96:99], v9, s[44:47], s92 offen offset:0 nt
    buffer_load_dwordx4 v[100:103], v9, s[44:47], s92 offen offset:1024 nt
    buffer_load_dwordx4 v[104:107], v9, s[44:47], s92 offen offset:2048 nt
    buffer_load_dwordx4 v[108:111], v9, s[44:47], s92 offen offset:3072 nt
    ds_read_b128 a[112:115], v10 offset:24576
    ds_read_b128 a[116:119], v11 offset:24576
    ds_read_b128 a[120:123], v12 offset:24576
    ds_read_b128 a[124:127], v13 offset:24576
    s_waitcnt lgkmcnt(3)
    v_mfma_f32_16x16x32_bf16 v[58:61], a[112:115], a[64:67], 0
    s_waitcnt lgkmcnt(2)
    v_mfma_f32_16x16x32_bf16 v[58:61], a[116:119], a[68:71], v[58:61]
    s_waitcnt lgkmcnt(1)
    v_mfma_f32_16x16x32_bf16 v[58:61], a[120:123], a[72:75], v[58:61]
    s_waitcnt lgkmcnt(0)
    v_mfma_f32_16x16x32_bf16 v[58:61], a[124:127], a[76:79], v[58:61]
    s_nop 7
    v_max3_f32 v50, v58, v59, v50
    v_max3_f32 v50, v60, v61, v50
    v_cvt_pk_bf16_f32 v46, v58, v59
    v_cvt_pk_bf16_f32 v47, v60, v61
    v_lshlrev_b32 v58, 16, v46
    v_and_b32 v59, 0xffff0000, v46
    v_lshlrev_b32 v60, 16, v47
    v_and_b32 v61, 0xffff0000, v47
    v_mul_f32 v58, s79, v58
    v_mul_f32 v59, s79, v59
    v_mul_f32 v60, s79, v60
    v_mul_f32 v61, s79, v61
    v_cvt_pk_bf16_f32 v46, v58, v59
    v_cvt_pk_bf16_f32 v47, v60, v61
    s_waitcnt vmcnt(8)
    s_mul_i32 s92, s86, 7
    s_add_u32 s92, s92, s83
    s_and_b32 s92, s92, 0xffffff
    s_or_b32 s92, s92, s25
    buffer_load_dwordx4 v[112:115], v9, s[44:47], s92 offen offset:0 nt
    buffer_load_dwordx4 v[116:119], v9, s[44:47], s92 offen offset:1024 nt
    buffer_load_dwordx4 v[120:123], v9, s[44:47], s92 offen offset:2048 nt
    buffer_load_dwordx4 v[124:127], v9, s[44:47], s92 offen offset:3072 nt
    ds_read_b128 a[96:99], v10 offset:28672
    ds_read_b128 a[100:103], v11 offset:28672
    ds_read_b128 a[104:107], v12 offset:28672
    ds_read_b128 a[108:111], v13 offset:28672
    s_waitcnt lgkmcnt(3)
    v_mfma_f32_16x16x32_bf16 v[54:57], a[96:99], a[64:67], 0
    s_waitcnt lgkmcnt(2)
    v_mfma_f32_16x16x32_bf16 v[54:57], a[100:103], a[68:71], v[54:57]
    s_waitcnt lgkmcnt(1)
    v_mfma_f32_16x16x32_bf16 v[54:57], a[104:107], a[72:75], v[54:57]
    s_waitcnt lgkmcnt(0)
    v_mfma_f32_16x16x32_bf16 v[54:57], a[108:111], a[76:79], v[54:57]
    s_nop 7
    v_max3_f32 v50, v54, v55, v50
    v_max3_f32 v50, v56, v57, v50
    v_cvt_pk_bf16_f32 v48, v54, v55
    v_cvt_pk_bf16_f32 v49, v56, v57
    v_lshlrev_b32 v54, 16, v48
    v_and_b32 v55, 0xffff0000, v48
    v_lshlrev_b32 v56, 16, v49
    v_and_b32 v57, 0xffff0000, v49
    v_mul_f32 v54, s79, v54
    v_mul_f32 v55, s79, v55
    v_mul_f32 v56, s79, v56
    v_mul_f32 v57, s79, v57
    v_cvt_pk_bf16_f32 v48, v54, v55
    v_cvt_pk_bf16_f32 v49, v56, v57
    v_mov_b32 v54, v50
    v_mov_b32 v55, v51
    s_nop 0
    v_permlane32_swap_b32 v54, v50
    v_permlane32_swap_b32 v55, v51
    v_max_f32 v50, v54, v50
    v_max_f32 v51, v55, v51
    v_mov_b32 v54, v50
    v_mov_b32 v55, v51
    s_nop 0
    v_permlane16_swap_b32 v54, v50
    v_permlane16_swap_b32 v55, v51
    v_max_f32 v50, v54, v50
    v_max_f32 v51, v55, v51
    v_cmp_eq_u32 vcc, 1, v2
    s_lshl_b32 s89, s3, 2
    s_add_u32 s89, s89, 152576
    v_lshl_add_u32 v15, v14, 4, s89
    v_cndmask_b32 v54, v50, v51, vcc
    s_mov_b32 exec_hi, 0
    ds_write_b32 v15, v54
    s_mov_b64 exec, -1
    s_waitcnt lgkmcnt(0)
    s_barrier
    v_lshlrev_b32 v15, 4, v1
    v_add_u32 v15, 152576, v15
    ds_read_b128 v[54:57], v15
    ds_read_b128 v[58:61], v15 offset:256
    s_waitcnt lgkmcnt(0)
    v_max3_f32 v50, v54, v55, v56
    v_max3_f32 v51, v58, v59, v60
    v_max_f32 v50, v50, v57
    v_max_f32 v51, v51, v61
    s_cmp_eq_u32 s24, 1
    s_cbranch_scc1 L_maxsep
    v_max_f32 v50, v50, v51
    v_mov_b32 v51, v50
L_maxsep:
    v_cvt_pk_bf16_f32 v54, v50, v51
    v_lshlrev_b32 v50, 16, v54
    v_and_b32 v51, 0xffff0000, v54
    v_mul_f32 v50, s79, v50
    v_mul_f32 v51, s79, v51
    v_cvt_pk_bf16_f32 v54, v50, v51
    v_lshlrev_b32 v50, 16, v54
    v_and_b32 v51, 0xffff0000, v54
    v_mul_f32 v10, s80, v50
    v_mul_f32 v11, s80, v51
    v_lshlrev_b32 v54, 16, v16
    v_and_b32 v55, 0xffff0000, v16
    v_lshlrev_b32 v56, 16, v17
    v_and_b32 v57, 0xffff0000, v17
    v_fma_f32 v54, v54, s80, -v10
    v_fma_f32 v55, v55, s80, -v10
    v_fma_f32 v56, v56, s80, -v10
    v_fma_f32 v57, v57, s80, -v10
    v_exp_f32 v54, v54
    v_exp_f32 v55, v55
    v_exp_f32 v56, v56
    v_exp_f32 v57, v57
    v_cvt_pk_bf16_f32 v16, v54, v55
    v_cvt_pk_bf16_f32 v17, v56, v57
    v_add_f32 v54, v54, v55
    v_add_f32 v56, v56, v57
    v_add_f32 v52, v52, v54
    v_add_f32 v52, v52, v56
    v_lshlrev_b32 v58, 16, v18
    v_and_b32 v59, 0xffff0000, v18
    v_lshlrev_b32 v60, 16, v19
    v_and_b32 v61, 0xffff0000, v19
    v_fma_f32 v58, v58, s80, -v11
    v_fma_f32 v59, v59, s80, -v11
    v_fma_f32 v60, v60, s80, -v11
    v_fma_f32 v61, v61, s80, -v11
    v_exp_f32 v58, v58
    v_exp_f32 v59, v59
    v_exp_f32 v60, v60
    v_exp_f32 v61, v61
    v_cvt_pk_bf16_f32 v18, v58, v59
    v_cvt_pk_bf16_f32 v19, v60, v61
    v_add_f32 v58, v58, v59
    v_add_f32 v60, v60, v61
    v_add_f32 v53, v53, v58
    v_add_f32 v53, v53, v60
    v_lshlrev_b32 v54, 16, v20
    v_and_b32 v55, 0xffff0000, v20
    v_lshlrev_b32 v56, 16, v21
    v_and_b32 v57, 0xffff0000, v21
    v_fma_f32 v54, v54, s80, -v11
    v_fma_f32 v55, v55, s80, -v11
    v_fma_f32 v56, v56, s80, -v11
    v_fma_f32 v57, v57, s80, -v11
    v_exp_f32 v54, v54
    v_exp_f32 v55, v55
    v_exp_f32 v56, v56
    v_exp_f32 v57, v57
    v_cvt_pk_bf16_f32 v20, v54, v55
    v_cvt_pk_bf16_f32 v21, v56, v57
    v_add_f32 v54, v54, v55
    v_add_f32 v56, v56, v57
    v_add_f32 v53, v53, v54
    v_add_f32 v53, v53, v56
    v_lshlrev_b32 v58, 16, v22
    v_and_b32 v59, 0xffff0000, v22
    v_lshlrev_b32 v60, 16, v23
    v_and_b32 v61, 0xffff0000, v23
    v_fma_f32 v58, v58, s80, -v11
    v_fma_f32 v59, v59, s80, -v11
    v_fma_f32 v60, v60, s80, -v11
    v_fma_f32 v61, v61, s80, -v11
    v_exp_f32 v58, v58
    v_exp_f32 v59, v59
    v_exp_f32 v60, v60
    v_exp_f32 v61, v61
    v_cvt_pk_bf16_f32 v22, v58, v59
    v_cvt_pk_bf16_f32 v23, v60, v61
    v_add_f32 v58, v58, v59
    v_add_f32 v60, v60, v61
    v_add_f32 v53, v53, v58
    v_add_f32 v53, v53, v60
    v_lshlrev_b32 v54, 16, v24
    v_and_b32 v55, 0xffff0000, v24
    v_lshlrev_b32 v56, 16, v25
    v_and_b32 v57, 0xffff0000, v25
    v_fma_f32 v54, v54, s80, -v11
    v_fma_f32 v55, v55, s80, -v11
    v_fma_f32 v56, v56, s80, -v11
    v_fma_f32 v57, v57, s80, -v11
    v_exp_f32 v54, v54
    v_exp_f32 v55, v55
    v_exp_f32 v56, v56
    v_exp_f32 v57, v57
    v_cvt_pk_bf16_f32 v24, v54, v55
    v_cvt_pk_bf16_f32 v25, v56, v57
    v_add_f32 v54, v54, v55
    v_add_f32 v56, v56, v57
    v_add_f32 v53, v53, v54
    v_add_f32 v53, v53, v56
    s_waitcnt vmcnt(8)
    s_add_u32 s92, s84, 0
    s_and_b32 s92, s92, 0xffffff
    s_or_b32 s92, s92, s25
    buffer_load_dwordx4 v[128:131], v9, s[52:55], s92 offen offset:0 nt
    buffer_load_dwordx4 v[132:135], v9, s[52:55], s92 offen offset:1024 nt
    buffer_load_dwordx4 v[136:139], v9, s[52:55], s92 offen offset:2048 nt
    buffer_load_dwordx4 v[140:143], v9, s[52:55], s92 offen offset:3072 nt
    v_lshlrev_b32 v58, 16, v26
    v_and_b32 v59, 0xffff0000, v26
    v_lshlrev_b32 v60, 16, v27
    v_and_b32 v61, 0xffff0000, v27
    v_fma_f32 v58, v58, s80, -v11
    v_fma_f32 v59, v59, s80, -v11
    v_fma_f32 v60, v60, s80, -v11
    v_fma_f32 v61, v61, s80, -v11
    v_exp_f32 v58, v58
    v_exp_f32 v59, v59
    v_exp_f32 v60, v60
    v_exp_f32 v61, v61
    v_cvt_pk_bf16_f32 v26, v58, v59
    v_cvt_pk_bf16_f32 v27, v60, v61
    v_add_f32 v58, v58, v59
    v_add_f32 v60, v60, v61
    v_add_f32 v53, v53, v58
    v_add_f32 v53, v53, v60
    v_lshlrev_b32 v54, 16, v28
    v_and_b32 v55, 0xffff0000, v28
    v_lshlrev_b32 v56, 16, v29
    v_and_b32 v57, 0xffff0000, v29
    v_fma_f32 v54, v54, s80, -v11
    v_fma_f32 v55, v55, s80, -v11
    v_fma_f32 v56, v56, s80, -v11
    v_fma_f32 v57, v57, s80, -v11
    v_exp_f32 v54, v54
    v_exp_f32 v55, v55
    v_exp_f32 v56, v56
    v_exp_f32 v57, v57
    v_cvt_pk_bf16_f32 v28, v54, v55
    v_cvt_pk_bf16_f32 v29, v56, v57
    v_add_f32 v54, v54, v55
    v_add_f32 v56, v56, v57
    v_add_f32 v53, v53, v54
    v_add_f32 v53, v53, v56
    v_lshlrev_b32 v58, 16, v30
    v_and_b32 v59, 0xffff0000, v30
    v_lshlrev_b32 v60, 16, v31
    v_and_b32 v61, 0xffff0000, v31
    v_fma_f32 v58, v58, s80, -v11
    v_fma_f32 v59, v59, s80, -v11
    v_fma_f32 v60, v60, s80, -v11
    v_fma_f32 v61, v61, s80, -v11
    v_exp_f32 v58, v58
    v_exp_f32 v59, v59
    v_exp_f32 v60, v60
    v_exp_f32 v61, v61
    v_cvt_pk_bf16_f32 v30, v58, v59
    v_cvt_pk_bf16_f32 v31, v60, v61
    v_add_f32 v58, v58, v59
    v_add_f32 v60, v60, v61
    v_add_f32 v53, v53, v58
    v_add_f32 v53, v53, v60
    v_lshlrev_b32 v54, 16, v32
    v_and_b32 v55, 0xffff0000, v32
    v_lshlrev_b32 v56, 16, v33
    v_and_b32 v57, 0xffff0000, v33
    v_fma_f32 v54, v54, s80, -v11
    v_fma_f32 v55, v55, s80, -v11
    v_fma_f32 v56, v56, s80, -v11
    v_fma_f32 v57, v57, s80, -v11
    v_exp_f32 v54, v54
    v_exp_f32 v55, v55
    v_exp_f32 v56, v56
    v_exp_f32 v57, v57
    v_cvt_pk_bf16_f32 v32, v54, v55
    v_cvt_pk_bf16_f32 v33, v56, v57
    v_add_f32 v54, v54, v55
    v_add_f32 v56, v56, v57
    v_add_f32 v53, v53, v54
    v_add_f32 v53, v53, v56
    v_lshlrev_b32 v58, 16, v34
    v_and_b32 v59, 0xffff0000, v34
    v_lshlrev_b32 v60, 16, v35
    v_and_b32 v61, 0xffff0000, v35
    v_fma_f32 v58, v58, s80, -v10
    v_fma_f32 v59, v59, s80, -v10
    v_fma_f32 v60, v60, s80, -v10
    v_fma_f32 v61, v61, s80, -v10
    v_exp_f32 v58, v58
    v_exp_f32 v59, v59
    v_exp_f32 v60, v60
    v_exp_f32 v61, v61
    v_cvt_pk_bf16_f32 v34, v58, v59
    v_cvt_pk_bf16_f32 v35, v60, v61
    v_add_f32 v58, v58, v59
    v_add_f32 v60, v60, v61
    v_add_f32 v52, v52, v58
    v_add_f32 v52, v52, v60
    v_lshlrev_b32 v54, 16, v36
    v_and_b32 v55, 0xffff0000, v36
    v_lshlrev_b32 v56, 16, v37
    v_and_b32 v57, 0xffff0000, v37
    v_fma_f32 v54, v54, s80, -v10
    v_fma_f32 v55, v55, s80, -v10
    v_fma_f32 v56, v56, s80, -v10
    v_fma_f32 v57, v57, s80, -v10
    v_exp_f32 v54, v54
    v_exp_f32 v55, v55
    v_exp_f32 v56, v56
    v_exp_f32 v57, v57
    v_cvt_pk_bf16_f32 v36, v54, v55
    v_cvt_pk_bf16_f32 v37, v56, v57
    v_add_f32 v54, v54, v55
    v_add_f32 v56, v56, v57
    v_add_f32 v52, v52, v54
    v_add_f32 v52, v52, v56
    v_lshlrev_b32 v58, 16, v38
    v_and_b32 v59, 0xffff0000, v38
    v_lshlrev_b32 v60, 16, v39
    v_and_b32 v61, 0xffff0000, v39
    v_fma_f32 v58, v58, s80, -v10
    v_fma_f32 v59, v59, s80, -v10
    v_fma_f32 v60, v60, s80, -v10
    v_fma_f32 v61, v61, s80, -v10
    v_exp_f32 v58, v58
    v_exp_f32 v59, v59
    v_exp_f32 v60, v60
    v_exp_f32 v61, v61
    v_cvt_pk_bf16_f32 v38, v58, v59
    v_cvt_pk_bf16_f32 v39, v60, v61
    v_add_f32 v58, v58, v59
    v_add_f32 v60, v60, v61
    v_add_f32 v52, v52, v58
    v_add_f32 v52, v52, v60
    v_lshlrev_b32 v54, 16, v40
    v_and_b32 v55, 0xffff0000, v40
    v_lshlrev_b32 v56, 16, v41
    v_and_b32 v57, 0xffff0000, v41
    v_fma_f32 v54, v54, s80, -v10
    v_fma_f32 v55, v55, s80, -v10
    v_fma_f32 v56, v56, s80, -v10
    v_fma_f32 v57, v57, s80, -v10
    v_exp_f32 v54, v54
    v_exp_f32 v55, v55
    v_exp_f32 v56, v56
    v_exp_f32 v57, v57
    v_cvt_pk_bf16_f32 v40, v54, v55
    v_cvt_pk_bf16_f32 v41, v56, v57
    v_add_f32 v54, v54, v55
    v_add_f32 v56, v56, v57
    v_add_f32 v52, v52, v54
    v_add_f32 v52, v52, v56
    v_lshlrev_b32 v58, 16, v42
    v_and_b32 v59, 0xffff0000, v42
    v_lshlrev_b32 v60, 16, v43
    v_and_b32 v61, 0xffff0000, v43
    v_fma_f32 v58, v58, s80, -v10
    v_fma_f32 v59, v59, s80, -v10
    v_fma_f32 v60, v60, s80, -v10
    v_fma_f32 v61, v61, s80, -v10
    v_exp_f32 v58, v58
    v_exp_f32 v59, v59
    v_exp_f32 v60, v60
    v_exp_f32 v61, v61
    v_cvt_pk_bf16_f32 v42, v58, v59
    v_cvt_pk_bf16_f32 v43, v60, v61
    v_add_f32 v58, v58, v59
    v_add_f32 v60, v60, v61
    v_add_f32 v52, v52, v58
    v_add_f32 v52, v52, v60
    v_lshlrev_b32 v54, 16, v44
    v_and_b32 v55, 0xffff0000, v44
    v_lshlrev_b32 v56, 16, v45
    v_and_b32 v57, 0xffff0000, v45
    v_fma_f32 v54, v54, s80, -v10
    v_fma_f32 v55, v55, s80, -v10
    v_fma_f32 v56, v56, s80, -v10
    v_fma_f32 v57, v57, s80, -v10
    v_exp_f32 v54, v54
    v_exp_f32 v55, v55
    v_exp_f32 v56, v56
    v_exp_f32 v57, v57
    v_cvt_pk_bf16_f32 v44, v54, v55
    v_cvt_pk_bf16_f32 v45, v56, v57
    v_add_f32 v54, v54, v55
    v_add_f32 v56, v56, v57
    v_add_f32 v52, v52, v54
    v_add_f32 v52, v52, v56
    v_lshlrev_b32 v58, 16, v46
    v_and_b32 v59, 0xffff0000, v46
    v_lshlrev_b32 v60, 16, v47
    v_and_b32 v61, 0xffff0000, v47
    v_fma_f32 v58, v58, s80, -v10
    v_fma_f32 v59, v59, s80, -v10
    v_fma_f32 v60, v60, s80, -v10
    v_fma_f32 v61, v61, s80, -v10
    v_exp_f32 v58, v58
    v_exp_f32 v59, v59
    v_exp_f32 v60, v60
    v_exp_f32 v61, v61
    v_cvt_pk_bf16_f32 v46, v58, v59
    v_cvt_pk_bf16_f32 v47, v60, v61
    v_add_f32 v58, v58, v59
    v_add_f32 v60, v60, v61
    v_add_f32 v52, v52, v58
    v_add_f32 v52, v52, v60
    v_lshlrev_b32 v54, 16, v48
    v_and_b32 v55, 0xffff0000, v48
    v_lshlrev_b32 v56, 16, v49
    v_and_b32 v57, 0xffff0000, v49
    v_fma_f32 v54, v54, s80, -v10
    v_fma_f32 v55, v55, s80, -v10
    v_fma_f32 v56, v56, s80, -v10
    v_fma_f32 v57, v57, s80, -v10
    v_exp_f32 v54, v54
    v_exp_f32 v55, v55
    v_exp_f32 v56, v56
    v_exp_f32 v57, v57
    v_cvt_pk_bf16_f32 v48, v54, v55
    v_cvt_pk_bf16_f32 v49, v56, v57
    v_add_f32 v54, v54, v55
    v_add_f32 v56, v56, v57
    v_add_f32 v52, v52, v54
    v_add_f32 v52, v52, v56
    s_waitcnt vmcnt(8)
    s_add_u32 s92, s84, 1048576
    s_and_b32 s92, s92, 0xffffff
    s_or_b32 s92, s92, s25
    buffer_load_dwordx4 v[144:147], v9, s[52:55], s92 offen offset:0 nt
    buffer_load_dwordx4 v[148:151], v9, s[52:55], s92 offen offset:1024 nt
    buffer_load_dwordx4 v[152:155], v9, s[52:55], s92 offen offset:2048 nt
    buffer_load_dwordx4 v[156:159], v9, s[52:55], s92 offen offset:3072 nt
    v_mov_b32 v54, v52
    v_mov_b32 v55, v53
    s_nop 0
    v_permlane32_swap_b32 v54, v52
    v_permlane32_swap_b32 v55, v53
    v_add_f32 v52, v54, v52
    v_add_f32 v53, v55, v53
    v_mov_b32 v54, v52
    v_mov_b32 v55, v53
    s_nop 0
    v_permlane16_swap_b32 v54, v52
    v_permlane16_swap_b32 v55, v53
    v_add_f32 v52, v54, v52
    v_add_f32 v53, v55, v53
    v_cmp_eq_u32 vcc, 1, v2
    s_lshl_b32 s89, s3, 2
    s_add_u32 s89, s89, 153088
    v_lshl_add_u32 v15, v14, 4, s89
    v_cndmask_b32 v54, v52, v53, vcc
    s_mov_b32 exec_hi, 0
    ds_write_b32 v15, v54
    s_mov_b64 exec, -1
    s_waitcnt lgkmcnt(0)
    s_barrier
    s_cmp_lg_u32 s3, 0
    s_cbranch_scc1 L_ml_done
    v_lshlrev_b32 v15, 4, v1
    v_add_u32 v15, 153088, v15
    ds_read_b128 v[54:57], v15
    ds_read_b128 v[58:61], v15 offset:256
    s_lshl_b32 s89, s81, 13
    s_lshl_b32 s90, s82, 4
    s_add_u32 s89, s89, s90
    s_add_u32 s89, s89, 163840
    v_lshlrev_b32 v15, 10, v1
    s_waitcnt lgkmcnt(0)
    v_add_f32 v54, v54, v55
    v_add_f32 v56, v56, v57
    v_add_f32 v58, v58, v59
    v_add_f32 v60, v60, v61
    v_add_f32 v52, v54, v56
    v_add_f32 v53, v58, v60
    s_mov_b64 exec, 0xff
    s_cmp_eq_u32 s24, 1
    s_cbranch_scc1 L_ml_a
    v_add_f32 v52, v52, v53
    s_branch L_ml_b
L_ml_a:
    s_lshl_b32 s90, s81, 10
    s_lshl_b32 s91, s26, 4
    s_add_u32 s90, s90, s91
    s_add_u32 s90, s90, 131072
    v_lshlrev_b32 v58, 7, v1
    v_bfi_b32 v54, s76, v0, v51
    v_bfi_b32 v55, s76, v4, v53
    v_bfi_b32 v56, s76, v62, v51
    v_bfi_b32 v57, s76, v63, v53
    buffer_store_dwordx4 v[54:57], v58, s[64:67], s90 offen sc1
    s_nop 1
L_ml_b:
    v_bfi_b32 v54, s76, v0, v50
    v_bfi_b32 v55, s76, v4, v52
    v_bfi_b32 v56, s76, v62, v50
    v_bfi_b32 v57, s76, v63, v52
    buffer_store_dwordx4 v[54:57], v15, s[64:67], s89 offen sc1
    s_mov_b64 exec, -1
    s_nop 1
L_ml_done:
    v_mul_u32_u24 v10, 528, v1
    v_lshl_add_u32 v10, v2, 7, v10
    v_add_u32 v10, s85, v10
    s_mul_i32 s89, s3, 1056
    v_lshrrev_b32 v11, 5, v14
    v_add_u32 v11, v11, v14
    v_lshl_add_u32 v11, v11, 4, s89
    v_add_u32 v12, 73728, v11
    v_lshlrev_b32 v13, 13, v2
    v_lshl_add_u32 v13, v1, 3, v13
    s_lshl_b32 s89, s81, 17
    s_lshl_b32 s90, s3, 15
    s_add_u32 s89, s89, s90
    s_lshl_b32 s90, s82, 7
    s_add_u32 s89, s89, s90
    s_add_u32 s100, s89, 1048576
    v_and_b32 v54, 15, v14
    v_lshlrev_b32 v54, 1, v54
    v_bfe_u32 v5, s17, v54, 1
    v_lshlrev_b32 v5, 16, v5
    v_bfe_u32 v55, s18, v54, 1
    v_or_b32 v5, v5, v55
    v_add_u32 v54, 1, v54
    v_bfe_u32 v6, s17, v54, 1
    v_lshlrev_b32 v6, 16, v6
    v_bfe_u32 v55, s18, v54, 1
    v_or_b32 v6, v6, v55
    v_perm_b32 v64, v164, v160, s77
    v_perm_b32 v65, v172, v168, s77
    v_perm_b32 v66, v180, v176, s77
    v_perm_b32 v67, v188, v184, s77
    v_perm_b32 v68, v164, v160, s78
    v_perm_b32 v69, v172, v168, s78
    v_perm_b32 v70, v180, v176, s78
    v_perm_b32 v71, v188, v184, s78
    v_mfma_f32_16x16x32_bf16 a[32:35], v[64:67], v[18:21], 0
    v_perm_b32 v72, v165, v161, s77
    v_perm_b32 v73, v173, v169, s77
    v_perm_b32 v74, v181, v177, s77
    v_perm_b32 v75, v189, v185, s77
    v_mfma_f32_16x16x32_bf16 a[36:39], v[68:71], v[18:21], 0
    v_perm_b32 v76, v165, v161, s78
    v_perm_b32 v77, v173, v169, s78
    v_perm_b32 v78, v181, v177, s78
    v_perm_b32 v79, v189, v185, s78
    v_mfma_f32_16x16x32_bf16 a[40:43], v[72:75], v[18:21], 0
    v_perm_b32 v80, v166, v162, s77
    v_perm_b32 v81, v174, v170, s77
    v_perm_b32 v82, v182, v178, s77
    v_perm_b32 v83, v190, v186, s77
    v_mfma_f32_16x16x32_bf16 a[44:47], v[76:79], v[18:21], 0
    v_perm_b32 v84, v166, v162, s78
    v_perm_b32 v85, v174, v170, s78
    v_perm_b32 v86, v182, v178, s78
    v_perm_b32 v87, v190, v186, s78
    v_mfma_f32_16x16x32_bf16 a[48:51], v[80:83], v[18:21], 0
    v_perm_b32 v88, v167, v163, s77
    v_perm_b32 v89, v175, v171, s77
    v_perm_b32 v90, v183, v179, s77
    v_perm_b32 v91, v191, v187, s77
    v_mfma_f32_16x16x32_bf16 a[52:55], v[84:87], v[18:21], 0
    v_perm_b32 v92, v167, v163, s78
    v_perm_b32 v93, v175, v171, s78
    v_perm_b32 v94, v183, v179, s78
    v_perm_b32 v95, v191, v187, s78
    v_mfma_f32_16x16x32_bf16 a[56:59], v[88:91], v[18:21], 0
    s_nop 0
    v_mfma_f32_16x16x32_bf16 a[60:63], v[92:95], v[18:21], 0
    v_perm_b32 v64, v196, v192, s77
    v_perm_b32 v65, v204, v200, s77
    v_perm_b32 v66, v212, v208, s77
    v_perm_b32 v67, v220, v216, s77
    v_perm_b32 v68, v196, v192, s78
    v_perm_b32 v69, v204, v200, s78
    v_perm_b32 v70, v212, v208, s78
    v_perm_b32 v71, v220, v216, s78
    v_mfma_f32_16x16x32_bf16 a[32:35], v[64:67], v[22:25], a[32:35]
    v_perm_b32 v72, v197, v193, s77
    v_perm_b32 v73, v205, v201, s77
    v_perm_b32 v74, v213, v209, s77
    v_perm_b32 v75, v221, v217, s77
    v_mfma_f32_16x16x32_bf16 a[36:39], v[68:71], v[22:25], a[36:39]
    v_perm_b32 v76, v197, v193, s78
    v_perm_b32 v77, v205, v201, s78
    v_perm_b32 v78, v213, v209, s78
    v_perm_b32 v79, v221, v217, s78
    v_mfma_f32_16x16x32_bf16 a[40:43], v[72:75], v[22:25], a[40:43]
    v_perm_b32 v80, v198, v194, s77
    v_perm_b32 v81, v206, v202, s77
    v_perm_b32 v82, v214, v210, s77
    v_perm_b32 v83, v222, v218, s77
    v_mfma_f32_16x16x32_bf16 a[44:47], v[76:79], v[22:25], a[44:47]
    v_perm_b32 v84, v198, v194, s78
    v_perm_b32 v85, v206, v202, s78
    v_perm_b32 v86, v214, v210, s78
    v_perm_b32 v87, v222, v218, s78
    v_mfma_f32_16x16x32_bf16 a[48:51], v[80:83], v[22:25], a[48:51]
    v_perm_b32 v88, v199, v195, s77
    v_perm_b32 v89, v207, v203, s77
    v_perm_b32 v90, v215, v211, s77
    v_perm_b32 v91, v223, v219, s77
    v_mfma_f32_16x16x32_bf16 a[52:55], v[84:87], v[22:25], a[52:55]
    v_perm_b32 v92, v199, v195, s78
    v_perm_b32 v93, v207, v203, s78
    v_perm_b32 v94, v215, v211, s78
    v_perm_b32 v95, v223, v219, s78
    v_mfma_f32_16x16x32_bf16 a[56:59], v[88:91], v[22:25], a[56:59]
    s_nop 0
    v_mfma_f32_16x16x32_bf16 a[60:63], v[92:95], v[22:25], a[60:63]
    v_perm_b32 v64, v228, v224, s77
    v_perm_b32 v65, v236, v232, s77
    v_perm_b32 v66, v244, v240, s77
    v_perm_b32 v67, v252, v248, s77
    v_perm_b32 v68, v228, v224, s78
    v_perm_b32 v69, v236, v232, s78
    v_perm_b32 v70, v244, v240, s78
    v_perm_b32 v71, v252, v248, s78
    v_mfma_f32_16x16x32_bf16 a[32:35], v[64:67], v[26:29], a[32:35]
    v_perm_b32 v72, v229, v225, s77
    v_perm_b32 v73, v237, v233, s77
    v_perm_b32 v74, v245, v241, s77
    v_perm_b32 v75, v253, v249, s77
    v_mfma_f32_16x16x32_bf16 a[36:39], v[68:71], v[26:29], a[36:39]
    v_perm_b32 v76, v229, v225, s78
    v_perm_b32 v77, v237, v233, s78
    v_perm_b32 v78, v245, v241, s78
    v_perm_b32 v79, v253, v249, s78
    v_mfma_f32_16x16x32_bf16 a[40:43], v[72:75], v[26:29], a[40:43]
    v_perm_b32 v80, v230, v226, s77
    v_perm_b32 v81, v238, v234, s77
    v_perm_b32 v82, v246, v242, s77
    v_perm_b32 v83, v254, v250, s77
    v_mfma_f32_16x16x32_bf16 a[44:47], v[76:79], v[26:29], a[44:47]
    v_perm_b32 v84, v230, v226, s78
    v_perm_b32 v85, v238, v234, s78
    v_perm_b32 v86, v246, v242, s78
    v_perm_b32 v87, v254, v250, s78
    v_mfma_f32_16x16x32_bf16 a[48:51], v[80:83], v[26:29], a[48:51]
    v_perm_b32 v88, v231, v227, s77
    v_perm_b32 v89, v239, v235, s77
    v_perm_b32 v90, v247, v243, s77
    v_perm_b32 v91, v255, v251, s77
    v_mfma_f32_16x16x32_bf16 a[52:55], v[84:87], v[26:29], a[52:55]
    v_perm_b32 v92, v231, v227, s78
    v_perm_b32 v93, v239, v235, s78
    v_perm_b32 v94, v247, v243, s78
    v_perm_b32 v95, v255, v251, s78
    v_mfma_f32_16x16x32_bf16 a[56:59], v[88:91], v[26:29], a[56:59]
    s_nop 0
    v_mfma_f32_16x16x32_bf16 a[60:63], v[92:95], v[26:29], a[60:63]
    s_waitcnt vmcnt(8)
    s_add_u32 s92, s84, 2097152
    s_and_b32 s92, s92, 0xffffff
    s_or_b32 s92, s92, s25
    buffer_load_dwordx4 v[160:163], v9, s[52:55], s92 offen offset:0 nt
    buffer_load_dwordx4 v[164:167], v9, s[52:55], s92 offen offset:1024 nt
    buffer_load_dwordx4 v[168:171], v9, s[52:55], s92 offen offset:2048 nt
    buffer_load_dwordx4 v[172:175], v9, s[52:55], s92 offen offset:3072 nt
    v_perm_b32 v64, v100, v96, s77
    v_perm_b32 v65, v108, v104, s77
    v_perm_b32 v66, v116, v112, s77
    v_perm_b32 v67, v124, v120, s77
    v_perm_b32 v68, v100, v96, s78
    v_perm_b32 v69, v108, v104, s78
    v_perm_b32 v70, v116, v112, s78
    v_perm_b32 v71, v124, v120, s78
    v_mfma_f32_16x16x32_bf16 a[32:35], v[64:67], v[30:33], a[32:35]
    v_perm_b32 v72, v101, v97, s77
    v_perm_b32 v73, v109, v105, s77
    v_perm_b32 v74, v117, v113, s77
    v_perm_b32 v75, v125, v121, s77
    v_mfma_f32_16x16x32_bf16 a[36:39], v[68:71], v[30:33], a[36:39]
    v_perm_b32 v76, v101, v97, s78
    v_perm_b32 v77, v109, v105, s78
    v_perm_b32 v78, v117, v113, s78
    v_perm_b32 v79, v125, v121, s78
    v_mfma_f32_16x16x32_bf16 a[40:43], v[72:75], v[30:33], a[40:43]
    v_perm_b32 v80, v102, v98, s77
    v_perm_b32 v81, v110, v106, s77
    v_perm_b32 v82, v118, v114, s77
    v_perm_b32 v83, v126, v122, s77
    v_mfma_f32_16x16x32_bf16 a[44:47], v[76:79], v[30:33], a[44:47]
    v_perm_b32 v84, v102, v98, s78
    v_perm_b32 v85, v110, v106, s78
    v_perm_b32 v86, v118, v114, s78
    v_perm_b32 v87, v126, v122, s78
    v_mfma_f32_16x16x32_bf16 a[48:51], v[80:83], v[30:33], a[48:51]
    v_perm_b32 v88, v103, v99, s77
    v_perm_b32 v89, v111, v107, s77
    v_perm_b32 v90, v119, v115, s77
    v_perm_b32 v91, v127, v123, s77
    v_mfma_f32_16x16x32_bf16 a[52:55], v[84:87], v[30:33], a[52:55]
    v_perm_b32 v92, v103, v99, s78
    v_perm_b32 v93, v111, v107, s78
    v_perm_b32 v94, v119, v115, s78
    v_perm_b32 v95, v127, v123, s78
    v_mfma_f32_16x16x32_bf16 a[56:59], v[88:91], v[30:33], a[56:59]
    s_nop 0
    v_mfma_f32_16x16x32_bf16 a[60:63], v[92:95], v[30:33], a[60:63]
    s_cmp_eq_u32 s24, 0
    s_cbranch_scc1 L_ap_done
    v_lshlrev_b32 v13, 10, v2
    v_lshl_add_u32 v13, v1, 3, v13
    s_lshl_b32 s89, s81, 14
    s_lshl_b32 s90, s3, 12
    s_add_u32 s89, s89, s90
    s_lshl_b32 s90, s26, 7
    s_add_u32 s89, s89, s90
    s_add_u32 s100, s89, 262144
    s_mov_b64 exec, s[96:97]
    ds_write_b128 v10, a[32:35] offset:0
    ds_write_b128 v10, a[36:39] offset:16
    ds_write_b128 v10, a[40:43] offset:32
    ds_write_b128 v10, a[44:47] offset:48
    ds_write_b128 v10, a[48:51] offset:64
    ds_write_b128 v10, a[52:55] offset:80
    ds_write_b128 v10, a[56:59] offset:96
    ds_write_b128 v10, a[60:63] offset:112
    s_mov_b64 exec, -1
    s_waitcnt lgkmcnt(0)
    s_barrier
    ds_read_b128 v[64:67], v11 offset:0
    ds_read_b128 v[68:71], v11 offset:36864
    ds_read_b128 v[72:75], v12 offset:0
    ds_read_b128 v[76:79], v12 offset:36864
    s_waitcnt lgkmcnt(2)
    v_add_f32 v64, v64, v68
    v_add_f32 v65, v65, v69
    v_add_f32 v66, v66, v70
    v_add_f32 v67, v67, v71
    s_waitcnt lgkmcnt(1)
    v_add_f32 v64, v64, v72
    v_add_f32 v65, v65, v73
    v_add_f32 v66, v66, v74
    v_add_f32 v67, v67, v75
    s_waitcnt lgkmcnt(0)
    v_add_f32 v64, v64, v76
    v_add_f32 v65, v65, v77
    v_add_f32 v66, v66, v78
    v_add_f32 v67, v67, v79
    v_cvt_pk_bf16_f32 v64, v64, v65
    v_cvt_pk_bf16_f32 v65, v66, v67
    v_bfi_b32 v64, s19, v5, v64
    v_bfi_b32 v65, s19, v6, v65
    buffer_store_dwordx2 v[64:65], v13, s[64:67], s100 offen sc1
    s_nop 0
    v_lshlrev_b32 v13, 13, v2
    v_lshl_add_u32 v13, v1, 3, v13
    s_lshl_b32 s89, s81, 17
    s_lshl_b32 s90, s3, 15
    s_add_u32 s89, s89, s90
    s_lshl_b32 s90, s82, 7
    s_add_u32 s89, s89, s90
    s_add_u32 s100, s89, 1048576
    v_accvgpr_write_b32 a32, 0
    v_accvgpr_write_b32 a33, 0
    v_accvgpr_write_b32 a34, 0
    v_accvgpr_write_b32 a35, 0
    v_accvgpr_write_b32 a36, 0
    v_accvgpr_write_b32 a37, 0
    v_accvgpr_write_b32 a38, 0
    v_accvgpr_write_b32 a39, 0
    v_accvgpr_write_b32 a40, 0
    v_accvgpr_write_b32 a41, 0
    v_accvgpr_write_b32 a42, 0
    v_accvgpr_write_b32 a43, 0
    v_accvgpr_write_b32 a44, 0
    v_accvgpr_write_b32 a45, 0
    v_accvgpr_write_b32 a46, 0
    v_accvgpr_write_b32 a47, 0
    v_accvgpr_write_b32 a48, 0
    v_accvgpr_write_b32 a49, 0
    v_accvgpr_write_b32 a50, 0
    v_accvgpr_write_b32 a51, 0
    v_accvgpr_write_b32 a52, 0
    v_accvgpr_write_b32 a53, 0
    v_accvgpr_write_b32 a54, 0
    v_accvgpr_write_b32 a55, 0
    v_accvgpr_write_b32 a56, 0
    v_accvgpr_write_b32 a57, 0
    v_accvgpr_write_b32 a58, 0
    v_accvgpr_write_b32 a59, 0
    v_accvgpr_write_b32 a60, 0
    v_accvgpr_write_b32 a61, 0
    v_accvgpr_write_b32 a62, 0
    v_accvgpr_write_b32 a63, 0
    s_barrier
L_ap_done:
    s_waitcnt vmcnt(8)
    s_add_u32 s92, s84, 3145728
    s_and_b32 s92, s92, 0xffffff
    s_or_b32 s92, s92, s25
    buffer_load_dwordx4 v[176:179], v9, s[52:55], s92 offen offset:0 nt
    buffer_load_dwordx4 v[180:183], v9, s[52:55], s92 offen offset:1024 nt
    buffer_load_dwordx4 v[184:187], v9, s[52:55], s92 offen offset:2048 nt
    buffer_load_dwordx4 v[188:191], v9, s[52:55], s92 offen offset:3072 nt
    v_perm_b32 v64, v132, v128, s77
    v_perm_b32 v65, v140, v136, s77
    v_perm_b32 v66, v132, v128, s78
    v_perm_b32 v67, v140, v136, s78
    v_perm_b32 v68, v133, v129, s77
    v_perm_b32 v69, v141, v137, s77
    v_mfma_f32_16x16x16_bf16 a[32:35], v[64:65], v[16:17], a[32:35]
    v_perm_b32 v70, v133, v129, s78
    v_perm_b32 v71, v141, v137, s78
    v_mfma_f32_16x16x16_bf16 a[36:39], v[66:67], v[16:17], a[36:39]
    v_perm_b32 v72, v134, v130, s77
    v_perm_b32 v73, v142, v138, s77
    v_mfma_f32_16x16x16_bf16 a[40:43], v[68:69], v[16:17], a[40:43]
    v_perm_b32 v74, v134, v130, s78
    v_perm_b32 v75, v142, v138, s78
    v_mfma_f32_16x16x16_bf16 a[44:47], v[70:71], v[16:17], a[44:47]
    v_perm_b32 v76, v135, v131, s77
    v_perm_b32 v77, v143, v139, s77
    v_mfma_f32_16x16x16_bf16 a[48:51], v[72:73], v[16:17], a[48:51]
    v_perm_b32 v78, v135, v131, s78
    v_perm_b32 v79, v143, v139, s78
    v_mfma_f32_16x16x16_bf16 a[52:55], v[74:75], v[16:17], a[52:55]
    v_mfma_f32_16x16x16_bf16 a[56:59], v[76:77], v[16:17], a[56:59]
    v_mfma_f32_16x16x16_bf16 a[60:63], v[78:79], v[16:17], a[60:63]
    s_waitcnt vmcnt(8)
    s_add_u32 s92, s84, 4194304
    s_and_b32 s92, s92, 0xffffff
    s_or_b32 s92, s92, s25
    buffer_load_dwordx4 v[192:195], v9, s[52:55], s92 offen offset:0 nt
    buffer_load_dwordx4 v[196:199], v9, s[52:55], s92 offen offset:1024 nt
    buffer_load_dwordx4 v[200:203], v9, s[52:55], s92 offen offset:2048 nt
    buffer_load_dwordx4 v[204:207], v9, s[52:55], s92 offen offset:3072 nt
    s_waitcnt vmcnt(8)
    s_add_u32 s92, s84, 5242880
    s_and_b32 s92, s92, 0xffffff
    s_or_b32 s92, s92, s25
    buffer_load_dwordx4 v[208:211], v9, s[52:55], s92 offen offset:0 nt
    buffer_load_dwordx4 v[212:215], v9, s[52:55], s92 offen offset:1024 nt
    buffer_load_dwordx4 v[216:219], v9, s[52:55], s92 offen offset:2048 nt
    buffer_load_dwordx4 v[220:223], v9, s[52:55], s92 offen offset:3072 nt
    v_perm_b32 v64, v148, v144, s77
    v_perm_b32 v65, v156, v152, s77
    v_perm_b32 v66, v164, v160, s77
    v_perm_b32 v67, v172, v168, s77
    v_perm_b32 v68, v148, v144, s78
    v_perm_b32 v69, v156, v152, s78
    v_perm_b32 v70, v164, v160, s78
    v_perm_b32 v71, v172, v168, s78
    v_mfma_f32_16x16x32_bf16 a[32:35], v[64:67], v[34:37], a[32:35]
    v_perm_b32 v72, v149, v145, s77
    v_perm_b32 v73, v157, v153, s77
    v_perm_b32 v74, v165, v161, s77
    v_perm_b32 v75, v173, v169, s77
    v_mfma_f32_16x16x32_bf16 a[36:39], v[68:71], v[34:37], a[36:39]
    v_perm_b32 v76, v149, v145, s78
    v_perm_b32 v77, v157, v153, s78
    v_perm_b32 v78, v165, v161, s78
    v_perm_b32 v79, v173, v169, s78
    v_mfma_f32_16x16x32_bf16 a[40:43], v[72:75], v[34:37], a[40:43]
    v_perm_b32 v80, v150, v146, s77
    v_perm_b32 v81, v158, v154, s77
    v_perm_b32 v82, v166, v162, s77
    v_perm_b32 v83, v174, v170, s77
    v_mfma_f32_16x16x32_bf16 a[44:47], v[76:79], v[34:37], a[44:47]
    v_perm_b32 v84, v150, v146, s78
    v_perm_b32 v85, v158, v154, s78
    v_perm_b32 v86, v166, v162, s78
    v_perm_b32 v87, v174, v170, s78
    v_mfma_f32_16x16x32_bf16 a[48:51], v[80:83], v[34:37], a[48:51]
    v_perm_b32 v88, v151, v147, s77
    v_perm_b32 v89, v159, v155, s77
    v_perm_b32 v90, v167, v163, s77
    v_perm_b32 v91, v175, v171, s77
    v_mfma_f32_16x16x32_bf16 a[52:55], v[84:87], v[34:37], a[52:55]
    v_perm_b32 v92, v151, v147, s78
    v_perm_b32 v93, v159, v155, s78
    v_perm_b32 v94, v167, v163, s78
    v_perm_b32 v95, v175, v171, s78
    v_mfma_f32_16x16x32_bf16 a[56:59], v[88:91], v[34:37], a[56:59]
    s_nop 0
    v_mfma_f32_16x16x32_bf16 a[60:63], v[92:95], v[34:37], a[60:63]
    s_waitcnt vmcnt(8)
    s_add_u32 s92, s84, 6291456
    s_and_b32 s92, s92, 0xffffff
    s_or_b32 s92, s92, s25
    buffer_load_dwordx4 v[224:227], v9, s[52:55], s92 offen offset:0 nt
    buffer_load_dwordx4 v[228:231], v9, s[52:55], s92 offen offset:1024 nt
    buffer_load_dwordx4 v[232:235], v9, s[52:55], s92 offen offset:2048 nt
    buffer_load_dwordx4 v[236:239], v9, s[52:55], s92 offen offset:3072 nt
    s_cmp_lg_u32 s3, 0
    s_cbranch_scc1 L_cl6
    s_lshl_b32 s89, s81, 8
    v_mov_b32 v8, 1
    v_mov_b32 v15, 0
    s_mov_b64 exec, 1
    buffer_atomic_add v8, v15, s[64:67], s89 offen offset:1024 sc0 sc1
    s_mov_b64 exec, -1
L_cl6:
    s_waitcnt vmcnt(8)
    s_add_u32 s92, s84, 7340032
    s_and_b32 s92, s92, 0xffffff
    s_or_b32 s92, s92, s25
    buffer_load_dwordx4 v[240:243], v9, s[52:55], s92 offen offset:0 nt
    buffer_load_dwordx4 v[244:247], v9, s[52:55], s92 offen offset:1024 nt
    buffer_load_dwordx4 v[248:251], v9, s[52:55], s92 offen offset:2048 nt
    buffer_load_dwordx4 v[252:255], v9, s[52:55], s92 offen offset:3072 nt
    v_perm_b32 v64, v180, v176, s77
    v_perm_b32 v65, v188, v184, s77
    v_perm_b32 v66, v196, v192, s77
    v_perm_b32 v67, v204, v200, s77
    v_perm_b32 v68, v180, v176, s78
    v_perm_b32 v69, v188, v184, s78
    v_perm_b32 v70, v196, v192, s78
    v_perm_b32 v71, v204, v200, s78
    v_mfma_f32_16x16x32_bf16 a[32:35], v[64:67], v[38:41], a[32:35]
    v_perm_b32 v72, v181, v177, s77
    v_perm_b32 v73, v189, v185, s77
    v_perm_b32 v74, v197, v193, s77
    v_perm_b32 v75, v205, v201, s77
    v_mfma_f32_16x16x32_bf16 a[36:39], v[68:71], v[38:41], a[36:39]
    v_perm_b32 v76, v181, v177, s78
    v_perm_b32 v77, v189, v185, s78
    v_perm_b32 v78, v197, v193, s78
    v_perm_b32 v79, v205, v201, s78
    v_mfma_f32_16x16x32_bf16 a[40:43], v[72:75], v[38:41], a[40:43]
    v_perm_b32 v80, v182, v178, s77
    v_perm_b32 v81, v190, v186, s77
    v_perm_b32 v82, v198, v194, s77
    v_perm_b32 v83, v206, v202, s77
    v_mfma_f32_16x16x32_bf16 a[44:47], v[76:79], v[38:41], a[44:47]
    v_perm_b32 v84, v182, v178, s78
    v_perm_b32 v85, v190, v186, s78
    v_perm_b32 v86, v198, v194, s78
    v_perm_b32 v87, v206, v202, s78
    v_mfma_f32_16x16x32_bf16 a[48:51], v[80:83], v[38:41], a[48:51]
    v_perm_b32 v88, v183, v179, s77
    v_perm_b32 v89, v191, v187, s77
    v_perm_b32 v90, v199, v195, s77
    v_perm_b32 v91, v207, v203, s77
    v_mfma_f32_16x16x32_bf16 a[52:55], v[84:87], v[38:41], a[52:55]
    v_perm_b32 v92, v183, v179, s78
    v_perm_b32 v93, v191, v187, s78
    v_perm_b32 v94, v199, v195, s78
    v_perm_b32 v95, v207, v203, s78
    v_mfma_f32_16x16x32_bf16 a[56:59], v[88:91], v[38:41], a[56:59]
    s_nop 0
    v_mfma_f32_16x16x32_bf16 a[60:63], v[92:95], v[38:41], a[60:63]
    s_waitcnt vmcnt(8)
    s_add_u32 s92, s84, 8388608
    s_and_b32 s92, s92, 0xffffff
    s_or_b32 s92, s92, s25
    buffer_load_dwordx4 v[96:99], v9, s[52:55], s92 offen offset:0 nt
    buffer_load_dwordx4 v[100:103], v9, s[52:55], s92 offen offset:1024 nt
    buffer_load_dwordx4 v[104:107], v9, s[52:55], s92 offen offset:2048 nt
    buffer_load_dwordx4 v[108:111], v9, s[52:55], s92 offen offset:3072 nt
    s_waitcnt vmcnt(8)
    v_perm_b32 v64, v212, v208, s77
    v_perm_b32 v65, v220, v216, s77
    v_perm_b32 v66, v228, v224, s77
    v_perm_b32 v67, v236, v232, s77
    v_perm_b32 v68, v212, v208, s78
    v_perm_b32 v69, v220, v216, s78
    v_perm_b32 v70, v228, v224, s78
    v_perm_b32 v71, v236, v232, s78
    v_mfma_f32_16x16x32_bf16 a[32:35], v[64:67], v[42:45], a[32:35]
    v_perm_b32 v72, v213, v209, s77
    v_perm_b32 v73, v221, v217, s77
    v_perm_b32 v74, v229, v225, s77
    v_perm_b32 v75, v237, v233, s77
    v_mfma_f32_16x16x32_bf16 a[36:39], v[68:71], v[42:45], a[36:39]
    v_perm_b32 v76, v213, v209, s78
    v_perm_b32 v77, v221, v217, s78
    v_perm_b32 v78, v229, v225, s78
    v_perm_b32 v79, v237, v233, s78
    v_mfma_f32_16x16x32_bf16 a[40:43], v[72:75], v[42:45], a[40:43]
    v_perm_b32 v80, v214, v210, s77
    v_perm_b32 v81, v222, v218, s77
    v_perm_b32 v82, v230, v226, s77
    v_perm_b32 v83, v238, v234, s77
    v_mfma_f32_16x16x32_bf16 a[44:47], v[76:79], v[42:45], a[44:47]
    v_perm_b32 v84, v214, v210, s78
    v_perm_b32 v85, v222, v218, s78
    v_perm_b32 v86, v230, v226, s78
    v_perm_b32 v87, v238, v234, s78
    v_mfma_f32_16x16x32_bf16 a[48:51], v[80:83], v[42:45], a[48:51]
    v_perm_b32 v88, v215, v211, s77
    v_perm_b32 v89, v223, v219, s77
    v_perm_b32 v90, v231, v227, s77
    v_perm_b32 v91, v239, v235, s77
    v_mfma_f32_16x16x32_bf16 a[52:55], v[84:87], v[42:45], a[52:55]
    v_perm_b32 v92, v215, v211, s78
    v_perm_b32 v93, v223, v219, s78
    v_perm_b32 v94, v231, v227, s78
    v_perm_b32 v95, v239, v235, s78
    v_mfma_f32_16x16x32_bf16 a[56:59], v[88:91], v[42:45], a[56:59]
    s_nop 0
    v_mfma_f32_16x16x32_bf16 a[60:63], v[92:95], v[42:45], a[60:63]
    s_waitcnt vmcnt(4)
    v_perm_b32 v64, v244, v240, s77
    v_perm_b32 v65, v252, v248, s77
    v_perm_b32 v66, v244, v240, s78
    v_perm_b32 v67, v252, v248, s78
    v_perm_b32 v68, v245, v241, s77
    v_perm_b32 v69, v253, v249, s77
    v_mfma_f32_16x16x16_bf16 a[32:35], v[64:65], v[46:47], a[32:35]
    v_perm_b32 v70, v245, v241, s78
    v_perm_b32 v71, v253, v249, s78
    v_mfma_f32_16x16x16_bf16 a[36:39], v[66:67], v[46:47], a[36:39]
    v_perm_b32 v72, v246, v242, s77
    v_perm_b32 v73, v254, v250, s77
    v_mfma_f32_16x16x16_bf16 a[40:43], v[68:69], v[46:47], a[40:43]
    v_perm_b32 v74, v246, v242, s78
    v_perm_b32 v75, v254, v250, s78
    v_mfma_f32_16x16x16_bf16 a[44:47], v[70:71], v[46:47], a[44:47]
    v_perm_b32 v76, v247, v243, s77
    v_perm_b32 v77, v255, v251, s77
    v_mfma_f32_16x16x16_bf16 a[48:51], v[72:73], v[46:47], a[48:51]
    v_perm_b32 v78, v247, v243, s78
    v_perm_b32 v79, v255, v251, s78
    v_mfma_f32_16x16x16_bf16 a[52:55], v[74:75], v[46:47], a[52:55]
    v_mfma_f32_16x16x16_bf16 a[56:59], v[76:77], v[46:47], a[56:59]
    v_mfma_f32_16x16x16_bf16 a[60:63], v[78:79], v[46:47], a[60:63]
    s_waitcnt vmcnt(0)
    v_perm_b32 v64, v100, v96, s77
    v_perm_b32 v65, v108, v104, s77
    v_perm_b32 v66, v100, v96, s78
    v_perm_b32 v67, v108, v104, s78
    v_perm_b32 v68, v101, v97, s77
    v_perm_b32 v69, v109, v105, s77
    v_mfma_f32_16x16x16_bf16 a[32:35], v[64:65], v[48:49], a[32:35]
    v_perm_b32 v70, v101, v97, s78
    v_perm_b32 v71, v109, v105, s78
    v_mfma_f32_16x16x16_bf16 a[36:39], v[66:67], v[48:49], a[36:39]
    v_perm_b32 v72, v102, v98, s77
    v_perm_b32 v73, v110, v106, s77
    v_mfma_f32_16x16x16_bf16 a[40:43], v[68:69], v[48:49], a[40:43]
    v_perm_b32 v74, v102, v98, s78
    v_perm_b32 v75, v110, v106, s78
    v_mfma_f32_16x16x16_bf16 a[44:47], v[70:71], v[48:49], a[44:47]
    v_perm_b32 v76, v103, v99, s77
    v_perm_b32 v77, v111, v107, s77
    v_mfma_f32_16x16x16_bf16 a[48:51], v[72:73], v[48:49], a[48:51]
    v_perm_b32 v78, v103, v99, s78
    v_perm_b32 v79, v111, v107, s78
    v_mfma_f32_16x16x16_bf16 a[52:55], v[74:75], v[48:49], a[52:55]
    v_mfma_f32_16x16x16_bf16 a[56:59], v[76:77], v[48:49], a[56:59]
    v_mfma_f32_16x16x16_bf16 a[60:63], v[78:79], v[48:49], a[60:63]
    s_mov_b64 exec, s[96:97]
    ds_write_b128 v10, a[32:35] offset:0
    ds_write_b128 v10, a[36:39] offset:16
    ds_write_b128 v10, a[40:43] offset:32
    ds_write_b128 v10, a[44:47] offset:48
    ds_write_b128 v10, a[48:51] offset:64
    ds_write_b128 v10, a[52:55] offset:80
    ds_write_b128 v10, a[56:59] offset:96
    ds_write_b128 v10, a[60:63] offset:112
    s_mov_b64 exec, -1
    s_cmp_lg_u32 s3, 0
    s_cbranch_scc1 L_cp7
    v_mov_b32 v15, 157184
    s_mov_b64 exec, 1
    ds_write_b32 v15, v8
    s_mov_b64 exec, -1
L_cp7:
    s_waitcnt lgkmcnt(0)
    s_barrier
    ds_read_b128 v[64:67], v11 offset:0
    ds_read_b128 v[68:71], v11 offset:36864
    ds_read_b128 v[72:75], v12 offset:0
    ds_read_b128 v[76:79], v12 offset:36864
    s_waitcnt lgkmcnt(2)
    v_add_f32 v64, v64, v68
    v_add_f32 v65, v65, v69
    v_add_f32 v66, v66, v70
    v_add_f32 v67, v67, v71
    s_waitcnt lgkmcnt(1)
    v_add_f32 v64, v64, v72
    v_add_f32 v65, v65, v73
    v_add_f32 v66, v66, v74
    v_add_f32 v67, v67, v75
    s_waitcnt lgkmcnt(0)
    v_add_f32 v64, v64, v76
    v_add_f32 v65, v65, v77
    v_add_f32 v66, v66, v78
    v_add_f32 v67, v67, v79
    v_cvt_pk_bf16_f32 v64, v64, v65
    v_cvt_pk_bf16_f32 v65, v66, v67
    v_bfi_b32 v64, s19, v5, v64
    v_bfi_b32 v65, s19, v6, v65
    buffer_store_dwordx2 v[64:65], v13, s[64:67], s100 offen sc1
    s_nop 0
    v_mov_b32 v15, 157184
    ds_read_b32 v15, v15
    v_lshrrev_b32 v3, 3, v14
    v_lshlrev_b32 v3, 14, v3
    v_and_b32 v54, 0x70, v9
    v_add_u32 v3, v3, v54
    s_waitcnt lgkmcnt(0)
    v_readfirstlane_b32 s90, v15
    s_nop 0
    s_lshl_b32 s20, s90, 2
    s_add_u32 s20, s20, s81
    s_add_u32 s21, s20, 232
    s_lshl_b32 s89, s81, 3
    s_and_b32 s91, s90, 7
    s_add_u32 s89, s89, s91
    s_add_u32 s91, s89, 32
    s_lshr_b32 s92, s90, 3
    s_cmp_eq_u32 s92, 1
    s_cselect_b32 s16, s89, 64
    s_cmp_eq_u32 s92, 7
    s_cselect_b32 s16, s91, s16
    s_cmp_ge_u32 s90, 58
    s_cbranch_scc1 L_none
    s_cmp_lt_u32 s90, 6
    s_cbranch_scc1 L_two
    v_lshrrev_b32 v20, 3, v9
    v_and_b32 v20, 0x70, v20
    s_lshr_b32 s89, s20, 2
    s_lshl_b32 s90, s89, 17
    s_lshl_b32 s91, s89, 10
    s_add_u32 s98, s91, 262144
    s_lshl_b32 s89, s89, 13
    s_lshl_b32 s92, s3, 11
    s_add_u32 s89, s89, s92
    s_add_u32 s93, s89, 1048576
    s_and_b32 s89, s20, 3
    s_lshl_b32 s89, s89, 9
    s_add_u32 s90, s90, s89
    s_lshl_b32 s89, s3, 7
    s_add_u32 s87, s90, s89
    s_lshr_b32 s89, s20, 3
    s_lshl_b32 s90, s89, 10
    s_add_u32 s27, s90, 163840
    s_lshl_b32 s89, s89, 7
    s_add_u32 s28, s89, 131072
    buffer_load_dwordx4 v[24:27], v20, s[64:67], s28 offen
    buffer_load_dwordx4 v[50:53], v9, s[64:67], s27 offen
    buffer_load_dwordx4 v[16:19], v9, s[64:67], s98 offen sc1
    s_add_u32 s92, s87, 0
    buffer_load_dwordx4 v[96:99], v3, s[56:59], s92 offen offset:0 nt
    buffer_load_dwordx4 v[100:103], v3, s[56:59], s92 offen offset:2048 nt
    s_add_u32 s92, s87, 4096
    buffer_load_dwordx4 v[104:107], v3, s[56:59], s92 offen offset:0 nt
    buffer_load_dwordx4 v[108:111], v3, s[56:59], s92 offen offset:2048 nt
    s_add_u32 s92, s87, 8192
    buffer_load_dwordx4 v[112:115], v3, s[56:59], s92 offen offset:0 nt
    buffer_load_dwordx4 v[116:119], v3, s[56:59], s92 offen offset:2048 nt
    s_add_u32 s92, s87, 12288
    buffer_load_dwordx4 v[120:123], v3, s[56:59], s92 offen offset:0 nt
    buffer_load_dwordx4 v[124:127], v3, s[56:59], s92 offen offset:2048 nt
    s_lshl_b32 s89, s20, 10
    s_lshl_b32 s90, s3, 8
    s_add_u32 s89, s89, s90
    s_add_u32 s101, s89, 1572864
    s_add_u32 s22, s101, 0x40000
    s_add_u32 s92, s87, 0
    buffer_load_dwordx4 v[128:131], v3, s[60:63], s92 offen offset:0 nt
    buffer_load_dwordx4 v[132:135], v3, s[60:63], s92 offen offset:2048 nt
    s_add_u32 s92, s87, 4096
    buffer_load_dwordx4 v[136:139], v3, s[60:63], s92 offen offset:0 nt
    buffer_load_dwordx4 v[140:143], v3, s[60:63], s92 offen offset:2048 nt
    s_add_u32 s92, s87, 8192
    buffer_load_dwordx4 v[144:147], v3, s[60:63], s92 offen offset:0 nt
    buffer_load_dwordx4 v[148:151], v3, s[60:63], s92 offen offset:2048 nt
    s_add_u32 s92, s87, 12288
    buffer_load_dwordx4 v[152:155], v3, s[60:63], s92 offen offset:0 nt
    buffer_load_dwordx4 v[156:159], v3, s[60:63], s92 offen offset:2048 nt
    v_and_b32 v36, 3, v14
    v_lshlrev_b32 v36, 1, v36
    v_bfe_u32 v37, v14, 2, 1
    v_lshl_add_u32 v36, v37, 5, v36
    v_and_b32 v37, 1, v2
    v_lshl_add_u32 v36, v37, 3, v36
    v_lshrrev_b32 v37, 1, v2
    v_add_u32 v36, v36, v37
    s_lshl_b32 s89, s3, 2
    s_add_u32 s89, s89, 153600
    v_lshl_add_u32 v36, v36, 4, s89
    v_and_b32 v38, 0x70, v9
    v_lshl_add_u32 v38, v37, 7, v38
    v_add_u32 v37, 153600, v9
    v_and_b32 v54, 7, v14
    v_lshlrev_b32 v54, 2, v54
    v_bfe_u32 v46, s17, v54, 1
    v_lshlrev_b32 v46, 16, v46
    v_bfe_u32 v55, s18, v54, 1
    v_or_b32 v46, v46, v55
    v_add_u32 v54, 1, v54
    v_bfe_u32 v47, s17, v54, 1
    v_lshlrev_b32 v47, 16, v47
    v_bfe_u32 v55, s18, v54, 1
    v_or_b32 v47, v47, v55
    v_add_u32 v54, 1, v54
    v_bfe_u32 v48, s17, v54, 1
    v_lshlrev_b32 v48, 16, v48
    v_bfe_u32 v55, s18, v54, 1
    v_or_b32 v48, v48, v55
    v_add_u32 v54, 1, v54
    v_bfe_u32 v49, s17, v54, 1
    v_lshlrev_b32 v49, 16, v49
    v_bfe_u32 v55, s18, v54, 1
    v_or_b32 v49, v49, v55
    s_waitcnt vmcnt(16)
    v_xor_b32 v15, s72, v50
    v_bitop3_b32 v15, v15, v51, s73 bitop3:0xf6
    v_bitop3_b32 v15, v15, v52, s74 bitop3:0xf6
    v_bitop3_b32 v15, v15, v53, s75 bitop3:0xf6
    v_and_b32 v15, s76, v15
    v_cmp_ne_u32 vcc, 0, v15
    s_cbranch_vccz L_ok8
    s_mov_b64 s[94:95], exec
    s_mov_b32 s88, 0
L_spin9:
    s_and_b64 exec, exec, vcc
    s_sleep 16
    buffer_load_dwordx4 v[50:53], v9, s[64:67], s27 offen sc1
    s_waitcnt vmcnt(0)
    v_xor_b32 v15, s72, v50
    v_bitop3_b32 v15, v15, v51, s73 bitop3:0xf6
    v_bitop3_b32 v15, v15, v52, s74 bitop3:0xf6
    v_bitop3_b32 v15, v15, v53, s75 bitop3:0xf6
    v_and_b32 v15, s76, v15
    v_cmp_ne_u32 vcc, 0, v15
    s_add_u32 s88, s88, 1
    s_cmp_ge_u32 s88, 20000
    s_cbranch_scc1 L_res10
    s_cbranch_vccnz L_spin9
L_res10:
    s_mov_b64 exec, s[94:95]
L_ok8:
    v_and_b32 v50, 0xffff0000, v50
    v_mov_b32 v54, v50
    v_mov_b32 v55, v54
    s_nop 1
    v_permlane32_swap_b32 v55, v54
    v_max_f32 v54, v55, v54
    v_mov_b32 v55, v54
    s_nop 1
    v_permlane16_swap_b32 v55, v54
    v_max_f32 v54, v55, v54
    s_nop 1
    v_max_f32_dpp v54, v54, v54 row_ror:8 row_mask:0xf bank_mask:0xf
    s_nop 1
    v_max_f32_dpp v54, v54, v54 row_ror:4 row_mask:0xf bank_mask:0xf
    s_nop 1
    v_max_f32_dpp v54, v54, v54 row_ror:2 row_mask:0xf bank_mask:0xf
    s_nop 1
    v_max_f32_dpp v54, v54, v54 row_ror:1 row_mask:0xf bank_mask:0xf
    v_sub_f32 v50, v50, v54
    v_mul_f32 v50, s80, v50
    v_exp_f32 v50, v50
    s_nop 0
    v_mul_f32 v54, v50, v51
    v_mov_b32 v55, v54
    s_nop 1
    v_permlane32_swap_b32 v55, v54
    v_add_f32 v54, v55, v54
    v_mov_b32 v55, v54
    s_nop 1
    v_permlane16_swap_b32 v55, v54
    v_add_f32 v54, v55, v54
    s_nop 1
    v_add_f32_dpp v54, v54, v54 row_ror:8 row_mask:0xf bank_mask:0xf
    s_nop 1
    v_add_f32_dpp v54, v54, v54 row_ror:4 row_mask:0xf bank_mask:0xf
    s_nop 1
    v_add_f32_dpp v54, v54, v54 row_ror:2 row_mask:0xf bank_mask:0xf
    s_nop 1
    v_add_f32_dpp v54, v54, v54 row_ror:1 row_mask:0xf bank_mask:0xf
    v_rcp_f32 v54, v54
    s_lshl_b32 s89, s3, 6
    v_lshrrev_b32 v15, 3, v14
    v_lshl_add_u32 v15, v15, 2, s89
    v_mul_f32 v50, v50, v54
    ds_bpermute_b32 v7, v15, v50
    ds_bpermute_b32 v39, v15, v50 offset:32
    s_waitcnt lgkmcnt(0)
    v_xor_b32 v15, s72, v24
    v_bitop3_b32 v15, v15, v25, s73 bitop3:0xf6
    v_bitop3_b32 v15, v15, v26, s74 bitop3:0xf6
    v_bitop3_b32 v15, v15, v27, s75 bitop3:0xf6
    v_and_b32 v15, s76, v15
    v_cmp_ne_u32 vcc, 0, v15
    s_cbranch_vccz L_ok13
    s_mov_b64 s[94:95], exec
    s_mov_b32 s88, 0
L_spin14:
    s_and_b64 exec, exec, vcc
    s_sleep 8
    buffer_load_dwordx4 v[24:27], v20, s[64:67], s28 offen sc1
    s_waitcnt vmcnt(0)
    v_xor_b32 v15, s72, v24
    v_bitop3_b32 v15, v15, v25, s73 bitop3:0xf6
    v_bitop3_b32 v15, v15, v26, s74 bitop3:0xf6
    v_bitop3_b32 v15, v15, v27, s75 bitop3:0xf6
    v_and_b32 v15, s76, v15
    v_cmp_ne_u32 vcc, 0, v15
    s_add_u32 s88, s88, 1
    s_cmp_ge_u32 s88, 20000
    s_cbranch_scc1 L_res15
    s_cbranch_vccnz L_spin14
L_res15:
    s_mov_b64 exec, s[94:95]
L_ok13:
    v_xor_b32 v15, v46, v16
    v_bitop3_b32 v15, v15, v17, v47 bitop3:0xf6
    v_bitop3_b32 v15, v15, v18, v48 bitop3:0xf6
    v_bitop3_b32 v15, v15, v19, v49 bitop3:0xf6
    v_and_b32 v15, s19, v15
    v_cmp_ne_u32 vcc, 0, v15
    s_nop 0
    s_wqm_b64 vcc, vcc
    s_lshr_b64 s[90:91], vcc, 4
    s_or_b64 vcc, vcc, s[90:91]
    s_and_b64 vcc, vcc, s[14:15]
    s_lshl_b64 s[90:91], vcc, 4
    s_or_b64 vcc, vcc, s[90:91]
    s_cbranch_vccz L_ok18
    s_mov_b64 s[94:95], exec
    s_mov_b32 s88, 0
L_spin19:
    s_and_b64 exec, exec, vcc
    s_sleep 8
    buffer_load_dwordx4 v[16:19], v9, s[64:67], s98 offen sc1
    s_waitcnt vmcnt(0)
    v_xor_b32 v15, v46, v16
    v_bitop3_b32 v15, v15, v17, v47 bitop3:0xf6
    v_bitop3_b32 v15, v15, v18, v48 bitop3:0xf6
    v_bitop3_b32 v15, v15, v19, v49 bitop3:0xf6
    v_and_b32 v15, s19, v15
    v_cmp_ne_u32 vcc, 0, v15
    s_nop 0
    s_wqm_b64 vcc, vcc
    s_lshr_b64 s[90:91], vcc, 4
    s_or_b64 vcc, vcc, s[90:91]
    s_and_b64 vcc, vcc, s[14:15]
    s_lshl_b64 s[90:91], vcc, 4
    s_or_b64 vcc, vcc, s[90:91]
    s_add_u32 s88, s88, 1
    s_cmp_ge_u32 s88, 20000
    s_cbranch_scc1 L_res20
    s_cbranch_vccnz L_spin19
L_res20:
    s_mov_b64 exec, s[94:95]
L_ok18:
    v_and_b32 v24, 0xffff0000, v24
    v_mov_b32 v54, v24
    v_mov_b32 v55, v54
    s_nop 1
    v_permlane32_swap_b32 v55, v54
    v_max_f32 v54, v55, v54
    v_mov_b32 v55, v54
    s_nop 1
    v_permlane16_swap_b32 v55, v54
    v_max_f32 v54, v55, v54
    s_nop 1
    v_max_f32_dpp v54, v54, v54 row_ror:8 row_mask:0xf bank_mask:0xf
    v_sub_f32 v24, v24, v54
    v_mul_f32 v24, s80, v24
    v_exp_f32 v24, v24
    s_nop 0
    v_mul_f32 v54, v24, v25
    v_mov_b32 v55, v54
    s_nop 1
    v_permlane32_swap_b32 v55, v54
    v_add_f32 v54, v55, v54
    v_mov_b32 v55, v54
    s_nop 1
    v_permlane16_swap_b32 v55, v54
    v_add_f32 v54, v55, v54
    s_nop 1
    v_add_f32_dpp v54, v54, v54 row_ror:8 row_mask:0xf bank_mask:0xf
    v_rcp_f32 v54, v54
    s_nop 0
    v_mul_f32 v24, v24, v54
    v_lshlrev_b32 v28, 16, v16
    v_and_b32 v29, 0xffff0000, v16
    v_lshlrev_b32 v30, 16, v17
    v_and_b32 v31, 0xffff0000, v17
    v_lshlrev_b32 v32, 16, v18
    v_and_b32 v33, 0xffff0000, v18
    v_lshlrev_b32 v34, 16, v19
    v_and_b32 v35, 0xffff0000, v19
    v_mul_f32 v28, v24, v28
    v_mul_f32 v29, v24, v29
    v_mul_f32 v30, v24, v30
    v_mul_f32 v31, v24, v31
    v_mul_f32 v32, v24, v32
    v_mul_f32 v33, v24, v33
    v_mul_f32 v34, v24, v34
    v_mul_f32 v35, v24, v35
    v_permlane32_swap_b32 v28, v32
    v_permlane32_swap_b32 v29, v33
    v_permlane32_swap_b32 v30, v34
    v_permlane32_swap_b32 v31, v35
    v_add_f32 v28, v28, v32
    v_add_f32 v29, v29, v33
    v_add_f32 v30, v30, v34
    v_add_f32 v31, v31, v35
    v_permlane16_swap_b32 v28, v29
    s_nop 0
    v_permlane16_swap_b32 v30, v31
    v_add_f32 v28, v28, v29
    v_add_f32 v30, v30, v31
    s_nop 0
    v_add_f32_dpp v28, v28, v28 row_ror:8 row_mask:0xf bank_mask:0xf
    v_add_f32_dpp v30, v30, v30 row_ror:8 row_mask:0xf bank_mask:0xf
    ds_write_b32 v36, v28 offset:0
    ds_write_b32 v36, v30 offset:256
    s_lshl_b32 s89, s3, 2
    v_add_u32 v29, s89, v37
    s_waitcnt lgkmcnt(0)
    ds_read_b32 v28, v29
    s_waitcnt lgkmcnt(0)
    v_mov_b32_dpp v29, v28 quad_perm:[1,0,3,2] row_mask:0xf bank_mask:0xf
    v_cvt_pk_bf16_f32 v28, v28, v29
    s_nop 1
    v_mov_b32_dpp v24, v28 row_newbcast:0 row_mask:0xf bank_mask:0x3
    v_mov_b32_dpp v25, v28 row_newbcast:2 row_mask:0xf bank_mask:0x3
    v_mov_b32_dpp v26, v28 row_newbcast:4 row_mask:0xf bank_mask:0x3
    v_mov_b32_dpp v27, v28 row_newbcast:6 row_mask:0xf bank_mask:0x3
    v_mov_b32_dpp v24, v28 row_newbcast:8 row_mask:0xf bank_mask:0xc
    v_mov_b32_dpp v25, v28 row_newbcast:10 row_mask:0xf bank_mask:0xc
    v_mov_b32_dpp v26, v28 row_newbcast:12 row_mask:0xf bank_mask:0xc
    v_mov_b32_dpp v27, v28 row_newbcast:14 row_mask:0xf bank_mask:0xc
    s_waitcnt vmcnt(8)
    buffer_load_dwordx4 v[16:19], v9, s[64:67], s93 offen offset:0 sc1
    buffer_load_dwordx4 v[20:23], v9, s[64:67], s93 offen offset:1024 sc1
    v_perm_b32 v64, v100, v96, s77
    v_perm_b32 v65, v108, v104, s77
    v_perm_b32 v66, v116, v112, s77
    v_perm_b32 v67, v124, v120, s77
    v_perm_b32 v68, v100, v96, s78
    v_perm_b32 v69, v108, v104, s78
    v_perm_b32 v70, v116, v112, s78
    v_perm_b32 v71, v124, v120, s78
    v_perm_b32 v72, v101, v97, s77
    v_perm_b32 v73, v109, v105, s77
    v_perm_b32 v74, v117, v113, s77
    v_perm_b32 v75, v125, v121, s77
    v_perm_b32 v76, v101, v97, s78
    v_perm_b32 v77, v109, v105, s78
    v_perm_b32 v78, v117, v113, s78
    v_perm_b32 v79, v125, v121, s78
    v_perm_b32 v80, v102, v98, s77
    v_perm_b32 v81, v110, v106, s77
    v_perm_b32 v82, v118, v114, s77
    v_perm_b32 v83, v126, v122, s77
    v_perm_b32 v84, v102, v98, s78
    v_perm_b32 v85, v110, v106, s78
    v_perm_b32 v86, v118, v114, s78
    v_perm_b32 v87, v126, v122, s78
    v_perm_b32 v88, v103, v99, s77
    v_perm_b32 v89, v111, v107, s77
    v_perm_b32 v90, v119, v115, s77
    v_perm_b32 v91, v127, v123, s77
    v_perm_b32 v92, v103, v99, s78
    v_perm_b32 v93, v111, v107, s78
    v_perm_b32 v94, v119, v115, s78
    v_perm_b32 v95, v127, v123, s78
    v_mfma_f32_16x16x32_bf16 v[96:99], v[24:27], v[64:67], 0
    v_mfma_f32_16x16x32_bf16 v[112:115], v[24:27], v[80:83], 0
    v_mfma_f32_16x16x32_bf16 v[100:103], v[24:27], v[68:71], 0
    v_mfma_f32_16x16x32_bf16 v[116:119], v[24:27], v[84:87], 0
    v_mfma_f32_16x16x32_bf16 v[104:107], v[24:27], v[72:75], 0
    v_mfma_f32_16x16x32_bf16 v[120:123], v[24:27], v[88:91], 0
    v_mfma_f32_16x16x32_bf16 v[108:111], v[24:27], v[76:79], 0
    v_mfma_f32_16x16x32_bf16 v[124:127], v[24:27], v[92:95], 0
    s_nop 1
    v_permlane32_swap_b32 v96, v112
    s_nop 0
    v_permlane32_swap_b32 v100, v116
    s_nop 0
    v_permlane32_swap_b32 v104, v120
    s_nop 0
    v_permlane32_swap_b32 v108, v124
    v_add_f32_dpp v96, v112, v96 row_ror:8 row_mask:0xf bank_mask:0xf
    v_add_f32_dpp v100, v116, v100 row_ror:8 row_mask:0xf bank_mask:0xf
    v_add_f32_dpp v104, v120, v104 row_ror:8 row_mask:0xf bank_mask:0xf
    v_add_f32_dpp v108, v124, v108 row_ror:8 row_mask:0xf bank_mask:0xf
    v_bfi_b32 v24, s76, v0, v96
    v_bfi_b32 v25, s76, v4, v100
    v_bfi_b32 v26, s76, v62, v104
    v_bfi_b32 v27, s76, v63, v108
    s_waitcnt vmcnt(6)
    buffer_load_dwordx4 v[16:19], v9, s[64:67], s93 offen offset:0 sc1
    buffer_load_dwordx4 v[20:23], v9, s[64:67], s93 offen offset:1024 sc1
    s_waitcnt vmcnt(4)
    v_perm_b32 v64, v132, v128, s77
    v_perm_b32 v65, v140, v136, s77
    v_perm_b32 v66, v148, v144, s77
    v_perm_b32 v67, v156, v152, s77
    v_perm_b32 v68, v132, v128, s78
    v_perm_b32 v69, v140, v136, s78
    v_perm_b32 v70, v148, v144, s78
    v_perm_b32 v71, v156, v152, s78
    v_perm_b32 v72, v133, v129, s77
    v_perm_b32 v73, v141, v137, s77
    v_perm_b32 v74, v149, v145, s77
    v_perm_b32 v75, v157, v153, s77
    v_perm_b32 v76, v133, v129, s78
    v_perm_b32 v77, v141, v137, s78
    v_perm_b32 v78, v149, v145, s78
    v_perm_b32 v79, v157, v153, s78
    v_perm_b32 v80, v134, v130, s77
    v_perm_b32 v81, v142, v138, s77
    v_perm_b32 v82, v150, v146, s77
    v_perm_b32 v83, v158, v154, s77
    v_perm_b32 v84, v134, v130, s78
    v_perm_b32 v85, v142, v138, s78
    v_perm_b32 v86, v150, v146, s78
    v_perm_b32 v87, v158, v154, s78
    v_perm_b32 v88, v135, v131, s77
    v_perm_b32 v89, v143, v139, s77
    v_perm_b32 v90, v151, v147, s77
    v_perm_b32 v91, v159, v155, s77
    v_perm_b32 v92, v135, v131, s78
    v_perm_b32 v93, v143, v139, s78
    v_perm_b32 v94, v151, v147, s78
    v_perm_b32 v95, v159, v155, s78
    s_waitcnt vmcnt(2)
    v_xor_b32 v15, v46, v16
    v_bitop3_b32 v15, v15, v17, v47 bitop3:0xf6
    v_bitop3_b32 v15, v15, v18, v48 bitop3:0xf6
    v_bitop3_b32 v15, v15, v19, v49 bitop3:0xf6
    v_bitop3_b32 v15, v15, v20, v46 bitop3:0xf6
    v_bitop3_b32 v15, v15, v21, v47 bitop3:0xf6
    v_bitop3_b32 v15, v15, v22, v48 bitop3:0xf6
    v_bitop3_b32 v15, v15, v23, v49 bitop3:0xf6
    v_and_b32 v15, s19, v15
    v_cmp_ne_u32 vcc, 0, v15
    s_nop 0
    s_wqm_b64 vcc, vcc
    s_lshr_b64 s[90:91], vcc, 4
    s_or_b64 vcc, vcc, s[90:91]
    s_and_b64 vcc, vcc, s[14:15]
    s_lshl_b64 s[90:91], vcc, 4
    s_or_b64 vcc, vcc, s[90:91]
    s_cbranch_vccz L_ok23
    s_mov_b64 s[94:95], exec
    s_mov_b32 s88, 0
L_spin24:
    s_and_b64 exec, exec, vcc
    s_bcnt1_i32_b64 s29, vcc
    s_cmp_le_u32 s29, 16
    s_cbranch_scc1 L_fast26
    s_sleep 8
L_nb28:
    buffer_load_dwordx4 v[16:19], v9, s[64:67], s93 offen offset:0 sc1
    buffer_load_dwordx4 v[20:23], v9, s[64:67], s93 offen offset:1024 sc1
    s_waitcnt vmcnt(0)
    v_xor_b32 v15, v46, v16
    v_bitop3_b32 v15, v15, v17, v47 bitop3:0xf6
    v_bitop3_b32 v15, v15, v18, v48 bitop3:0xf6
    v_bitop3_b32 v15, v15, v19, v49 bitop3:0xf6
    v_bitop3_b32 v15, v15, v20, v46 bitop3:0xf6
    v_bitop3_b32 v15, v15, v21, v47 bitop3:0xf6
    v_bitop3_b32 v15, v15, v22, v48 bitop3:0xf6
    v_bitop3_b32 v15, v15, v23, v49 bitop3:0xf6
    v_and_b32 v15, s19, v15
    v_cmp_ne_u32 vcc, 0, v15
    s_nop 0
    s_wqm_b64 vcc, vcc
    s_lshr_b64 s[90:91], vcc, 4
    s_or_b64 vcc, vcc, s[90:91]
    s_and_b64 vcc, vcc, s[14:15]
    s_lshl_b64 s[90:91], vcc, 4
    s_or_b64 vcc, vcc, s[90:91]
    s_add_u32 s88, s88, 1
    s_cmp_ge_u32 s88, 20000
    s_cbranch_scc1 L_res25
    s_cbranch_vccnz L_spin24
    s_branch L_res25
L_fast26:
    buffer_load_dwordx4 v[16:19], v9, s[64:67], s93 offen offset:0 sc1
    buffer_load_dwordx4 v[20:23], v9, s[64:67], s93 offen offset:1024 sc1
    s_sleep 3
    buffer_load_dwordx4 v[16:19], v9, s[64:67], s93 offen offset:0 sc1
    buffer_load_dwordx4 v[20:23], v9, s[64:67], s93 offen offset:1024 sc1
    s_sleep 3
    buffer_load_dwordx4 v[16:19], v9, s[64:67], s93 offen offset:0 sc1
    buffer_load_dwordx4 v[20:23], v9, s[64:67], s93 offen offset:1024 sc1
    s_sleep 3
L_floop27:
    buffer_load_dwordx4 v[16:19], v9, s[64:67], s93 offen offset:0 sc1
    buffer_load_dwordx4 v[20:23], v9, s[64:67], s93 offen offset:1024 sc1
    s_waitcnt vmcnt(6)
    v_xor_b32 v15, v46, v16
    v_bitop3_b32 v15, v15, v17, v47 bitop3:0xf6
    v_bitop3_b32 v15, v15, v18, v48 bitop3:0xf6
    v_bitop3_b32 v15, v15, v19, v49 bitop3:0xf6
    v_bitop3_b32 v15, v15, v20, v46 bitop3:0xf6
    v_bitop3_b32 v15, v15, v21, v47 bitop3:0xf6
    v_bitop3_b32 v15, v15, v22, v48 bitop3:0xf6
    v_bitop3_b32 v15, v15, v23, v49 bitop3:0xf6
    v_and_b32 v15, s19, v15
    v_cmp_ne_u32 vcc, 0, v15
    s_nop 0
    s_wqm_b64 vcc, vcc
    s_lshr_b64 s[90:91], vcc, 4
    s_or_b64 vcc, vcc, s[90:91]
    s_and_b64 vcc, vcc, s[14:15]
    s_lshl_b64 s[90:91], vcc, 4
    s_or_b64 vcc, vcc, s[90:91]
    s_add_u32 s88, s88, 1
    s_cmp_ge_u32 s88, 80000
    s_cbranch_scc1 L_res25
    s_and_b64 exec, exec, vcc
    s_cbranch_vccnz L_floop27
L_res25:
    s_mov_b64 exec, s[94:95]
L_ok23:
    s_mov_b32 exec_lo, 0xff
    s_mov_b32 exec_hi, 0xff
    buffer_store_dwordx4 v[24:27], v38, s[64:67], s101 offen sc1
    s_mov_b64 exec, -1
    v_lshlrev_b32 v28, 16, v16
    v_and_b32 v29, 0xffff0000, v16
    v_lshlrev_b32 v30, 16, v17
    v_and_b32 v31, 0xffff0000, v17
    v_lshlrev_b32 v32, 16, v18
    v_and_b32 v33, 0xffff0000, v18
    v_lshlrev_b32 v34, 16, v19
    v_and_b32 v35, 0xffff0000, v19
    v_mul_f32 v28, v7, v28
    v_mul_f32 v29, v7, v29
    v_mul_f32 v30, v7, v30
    v_mul_f32 v31, v7, v31
    v_mul_f32 v32, v7, v32
    v_mul_f32 v33, v7, v33
    v_mul_f32 v34, v7, v34
    v_mul_f32 v35, v7, v35
    v_lshlrev_b32 v5, 16, v20
    v_and_b32 v6, 0xffff0000, v20
    v_fmac_f32 v28, v39, v5
    v_fmac_f32 v29, v39, v6
    v_lshlrev_b32 v5, 16, v21
    v_and_b32 v6, 0xffff0000, v21
    v_fmac_f32 v30, v39, v5
    v_fmac_f32 v31, v39, v6
    v_lshlrev_b32 v5, 16, v22
    v_and_b32 v6, 0xffff0000, v22
    v_fmac_f32 v32, v39, v5
    v_fmac_f32 v33, v39, v6
    v_lshlrev_b32 v5, 16, v23
    v_and_b32 v6, 0xffff0000, v23
    v_fmac_f32 v34, v39, v5
    v_fmac_f32 v35, v39, v6
    v_permlane32_swap_b32 v28, v32
    v_permlane32_swap_b32 v29, v33
    v_permlane32_swap_b32 v30, v34
    v_permlane32_swap_b32 v31, v35
    v_add_f32 v28, v28, v32
    v_add_f32 v29, v29, v33
    v_add_f32 v30, v30, v34
    v_add_f32 v31, v31, v35
    v_permlane16_swap_b32 v28, v29
    s_nop 0
    v_permlane16_swap_b32 v30, v31
    v_add_f32 v28, v28, v29
    v_add_f32 v30, v30, v31
    s_nop 0
    v_add_f32_dpp v28, v28, v28 row_ror:8 row_mask:0xf bank_mask:0xf
    v_add_f32_dpp v30, v30, v30 row_ror:8 row_mask:0xf bank_mask:0xf
    ds_write_b32 v36, v28 offset:1024
    ds_write_b32 v36, v30 offset:1280
    s_waitcnt lgkmcnt(0)
    s_barrier
    ds_read_b128 v[28:31], v37 offset:1024
    s_waitcnt lgkmcnt(0)
    v_add_f32 v28, v28, v29
    v_add_f32 v30, v30, v31
    v_add_f32 v28, v28, v30
    s_nop 1
    v_mov_b32_dpp v29, v28 quad_perm:[1,0,3,2] row_mask:0xf bank_mask:0xf
    v_cvt_pk_bf16_f32 v28, v28, v29
    s_nop 1
    v_mov_b32_dpp v42, v28 row_newbcast:0 row_mask:0xf bank_mask:0x3
    v_mov_b32_dpp v43, v28 row_newbcast:2 row_mask:0xf bank_mask:0x3
    v_mov_b32_dpp v44, v28 row_newbcast:4 row_mask:0xf bank_mask:0x3
    v_mov_b32_dpp v45, v28 row_newbcast:6 row_mask:0xf bank_mask:0x3
    v_mov_b32_dpp v42, v28 row_newbcast:8 row_mask:0xf bank_mask:0xc
    v_mov_b32_dpp v43, v28 row_newbcast:10 row_mask:0xf bank_mask:0xc
    v_mov_b32_dpp v44, v28 row_newbcast:12 row_mask:0xf bank_mask:0xc
    v_mov_b32_dpp v45, v28 row_newbcast:14 row_mask:0xf bank_mask:0xc
    s_nop 1
    v_mfma_f32_16x16x32_bf16 v[128:131], v[42:45], v[64:67], 0
    v_mfma_f32_16x16x32_bf16 v[144:147], v[42:45], v[80:83], 0
    v_mfma_f32_16x16x32_bf16 v[132:135], v[42:45], v[68:71], 0
    v_mfma_f32_16x16x32_bf16 v[148:151], v[42:45], v[84:87], 0
    v_mfma_f32_16x16x32_bf16 v[136:139], v[42:45], v[72:75], 0
    v_mfma_f32_16x16x32_bf16 v[152:155], v[42:45], v[88:91], 0
    v_mfma_f32_16x16x32_bf16 v[140:143], v[42:45], v[76:79], 0
    v_mfma_f32_16x16x32_bf16 v[156:159], v[42:45], v[92:95], 0
    s_nop 1
    v_permlane32_swap_b32 v128, v144
    s_nop 0
    v_permlane32_swap_b32 v132, v148
    s_nop 0
    v_permlane32_swap_b32 v136, v152
    s_nop 0
    v_permlane32_swap_b32 v140, v156
    v_add_f32_dpp v128, v144, v128 row_ror:8 row_mask:0xf bank_mask:0xf
    v_add_f32_dpp v132, v148, v132 row_ror:8 row_mask:0xf bank_mask:0xf
    v_add_f32_dpp v136, v152, v136 row_ror:8 row_mask:0xf bank_mask:0xf
    v_add_f32_dpp v140, v156, v140 row_ror:8 row_mask:0xf bank_mask:0xf
    v_bfi_b32 v28, s76, v0, v128
    v_bfi_b32 v29, s76, v4, v132
    v_bfi_b32 v30, s76, v62, v136
    v_bfi_b32 v31, s76, v63, v140
    s_mov_b32 exec_lo, 0xff
    s_mov_b32 exec_hi, 0xff
    buffer_store_dwordx4 v[28:31], v38, s[64:67], s22 offen sc1
    s_mov_b64 exec, -1
    s_branch L_pub
L_two:
    v_lshrrev_b32 v20, 3, v9
    v_and_b32 v20, 0x70, v20
    s_lshr_b32 s89, s20, 2
    s_lshl_b32 s90, s89, 17
    s_lshl_b32 s91, s89, 10
    s_add_u32 s98, s91, 262144
    s_lshl_b32 s89, s89, 13
    s_lshl_b32 s92, s3, 11
    s_add_u32 s89, s89, s92
    s_add_u32 s93, s89, 1048576
    s_and_b32 s89, s20, 3
    s_lshl_b32 s89, s89, 9
    s_add_u32 s90, s90, s89
    s_lshl_b32 s89, s3, 7
    s_add_u32 s87, s90, s89
    s_lshr_b32 s89, s20, 3
    s_lshl_b32 s90, s89, 10
    s_add_u32 s27, s90, 163840
    s_lshl_b32 s89, s89, 7
    s_add_u32 s28, s89, 131072
    s_add_u32 s92, s87, 0
    buffer_load_dwordx4 v[96:99], v3, s[56:59], s92 offen offset:0 nt
    buffer_load_dwordx4 v[100:103], v3, s[56:59], s92 offen offset:2048 nt
    s_add_u32 s92, s87, 4096
    buffer_load_dwordx4 v[104:107], v3, s[56:59], s92 offen offset:0 nt
    buffer_load_dwordx4 v[108:111], v3, s[56:59], s92 offen offset:2048 nt
    s_add_u32 s92, s87, 8192
    buffer_load_dwordx4 v[112:115], v3, s[56:59], s92 offen offset:0 nt
    buffer_load_dwordx4 v[116:119], v3, s[56:59], s92 offen offset:2048 nt
    s_add_u32 s92, s87, 12288
    buffer_load_dwordx4 v[120:123], v3, s[56:59], s92 offen offset:0 nt
    buffer_load_dwordx4 v[124:127], v3, s[56:59], s92 offen offset:2048 nt
    s_add_u32 s92, s87, 0
    buffer_load_dwordx4 v[128:131], v3, s[60:63], s92 offen offset:0 nt
    buffer_load_dwordx4 v[132:135], v3, s[60:63], s92 offen offset:2048 nt
    s_add_u32 s92, s87, 4096
    buffer_load_dwordx4 v[136:139], v3, s[60:63], s92 offen offset:0 nt
    buffer_load_dwordx4 v[140:143], v3, s[60:63], s92 offen offset:2048 nt
    s_lshr_b32 s89, s21, 2
    s_lshl_b32 s90, s89, 17
    s_lshl_b32 s91, s89, 10
    s_add_u32 s99, s91, 262144
    s_lshl_b32 s89, s89, 13
    s_lshl_b32 s92, s3, 11
    s_add_u32 s89, s89, s92
    s_add_u32 s23, s89, 1048576
    s_and_b32 s89, s21, 3
    s_lshl_b32 s89, s89, 9
    s_add_u32 s90, s90, s89
    s_lshl_b32 s89, s3, 7
    s_add_u32 s31, s90, s89
    s_lshr_b32 s89, s21, 3
    s_lshl_b32 s90, s89, 10
    s_add_u32 s83, s90, 163840
    s_lshl_b32 s89, s89, 7
    s_add_u32 s84, s89, 131072
    v_and_b32 v36, 3, v14
    v_lshlrev_b32 v36, 1, v36
    v_bfe_u32 v37, v14, 2, 1
    v_lshl_add_u32 v36, v37, 5, v36
    v_and_b32 v37, 1, v2
    v_lshl_add_u32 v36, v37, 3, v36
    v_lshrrev_b32 v37, 1, v2
    v_add_u32 v36, v36, v37
    s_lshl_b32 s89, s3, 2
    s_add_u32 s89, s89, 153600
    v_lshl_add_u32 v36, v36, 4, s89
    v_and_b32 v38, 0x70, v9
    v_lshl_add_u32 v38, v37, 7, v38
    v_add_u32 v37, 153600, v9
    v_and_b32 v54, 7, v14
    v_lshlrev_b32 v54, 2, v54
    v_bfe_u32 v46, s17, v54, 1
    v_lshlrev_b32 v46, 16, v46
    v_bfe_u32 v55, s18, v54, 1
    v_or_b32 v46, v46, v55
    v_add_u32 v54, 1, v54
    v_bfe_u32 v47, s17, v54, 1
    v_lshlrev_b32 v47, 16, v47
    v_bfe_u32 v55, s18, v54, 1
    v_or_b32 v47, v47, v55
    v_add_u32 v54, 1, v54
    v_bfe_u32 v48, s17, v54, 1
    v_lshlrev_b32 v48, 16, v48
    v_bfe_u32 v55, s18, v54, 1
    v_or_b32 v48, v48, v55
    v_add_u32 v54, 1, v54
    v_bfe_u32 v49, s17, v54, 1
    v_lshlrev_b32 v49, 16, v49
    v_bfe_u32 v55, s18, v54, 1
    v_or_b32 v49, v49, v55
    s_lshl_b32 s89, s20, 10
    s_lshl_b32 s90, s3, 8
    s_add_u32 s89, s89, s90
    s_add_u32 s101, s89, 1572864
    s_lshl_b32 s89, s21, 10
    s_lshl_b32 s90, s3, 8
    s_add_u32 s89, s89, s90
    s_add_u32 s22, s89, 1572864
    s_waitcnt vmcnt(8)
    s_add_u32 s92, s87, 8192
    buffer_load_dwordx4 v[144:147], v3, s[60:63], s92 offen offset:0 nt
    buffer_load_dwordx4 v[148:151], v3, s[60:63], s92 offen offset:2048 nt
    s_add_u32 s92, s87, 12288
    buffer_load_dwordx4 v[152:155], v3, s[60:63], s92 offen offset:0 nt
    buffer_load_dwordx4 v[156:159], v3, s[60:63], s92 offen offset:2048 nt
    s_waitcnt vmcnt(8)
    s_add_u32 s92, s31, 0
    buffer_load_dwordx4 v[160:163], v3, s[56:59], s92 offen offset:0 nt
    buffer_load_dwordx4 v[164:167], v3, s[56:59], s92 offen offset:2048 nt
    s_add_u32 s92, s31, 4096
    buffer_load_dwordx4 v[168:171], v3, s[56:59], s92 offen offset:0 nt
    buffer_load_dwordx4 v[172:175], v3, s[56:59], s92 offen offset:2048 nt
    s_waitcnt vmcnt(8)
    s_add_u32 s92, s31, 8192
    buffer_load_dwordx4 v[176:179], v3, s[56:59], s92 offen offset:0 nt
    buffer_load_dwordx4 v[180:183], v3, s[56:59], s92 offen offset:2048 nt
    s_add_u32 s92, s31, 12288
    buffer_load_dwordx4 v[184:187], v3, s[56:59], s92 offen offset:0 nt
    buffer_load_dwordx4 v[188:191], v3, s[56:59], s92 offen offset:2048 nt
    buffer_load_dwordx4 v[24:27], v20, s[64:67], s28 offen
    buffer_load_dwordx4 v[50:53], v9, s[64:67], s27 offen
    buffer_load_dwordx4 v[16:19], v9, s[64:67], s98 offen sc1
    buffer_load_dwordx4 v[232:235], v20, s[64:67], s84 offen
    buffer_load_dwordx4 v[236:239], v9, s[64:67], s83 offen
    buffer_load_dwordx4 v[224:227], v9, s[64:67], s99 offen sc1
    s_waitcnt vmcnt(14)
    s_add_u32 s92, s31, 0
    buffer_load_dwordx4 v[192:195], v3, s[60:63], s92 offen offset:0 nt
    buffer_load_dwordx4 v[196:199], v3, s[60:63], s92 offen offset:2048 nt
    s_add_u32 s92, s31, 4096
    buffer_load_dwordx4 v[200:203], v3, s[60:63], s92 offen offset:0 nt
    buffer_load_dwordx4 v[204:207], v3, s[60:63], s92 offen offset:2048 nt
    s_waitcnt vmcnt(14)
    s_add_u32 s92, s31, 8192
    buffer_load_dwordx4 v[208:211], v3, s[60:63], s92 offen offset:0 nt
    buffer_load_dwordx4 v[212:215], v3, s[60:63], s92 offen offset:2048 nt
    s_add_u32 s92, s31, 12288
    buffer_load_dwordx4 v[216:219], v3, s[60:63], s92 offen offset:0 nt
    buffer_load_dwordx4 v[220:223], v3, s[60:63], s92 offen offset:2048 nt
    v_perm_b32 v64, v100, v96, s77
    v_perm_b32 v65, v108, v104, s77
    v_perm_b32 v66, v116, v112, s77
    v_perm_b32 v67, v124, v120, s77
    v_perm_b32 v68, v100, v96, s78
    v_perm_b32 v69, v108, v104, s78
    v_perm_b32 v70, v116, v112, s78
    v_perm_b32 v71, v124, v120, s78
    v_perm_b32 v72, v101, v97, s77
    v_perm_b32 v73, v109, v105, s77
    v_perm_b32 v74, v117, v113, s77
    v_perm_b32 v75, v125, v121, s77
    v_perm_b32 v76, v101, v97, s78
    v_perm_b32 v77, v109, v105, s78
    v_perm_b32 v78, v117, v113, s78
    v_perm_b32 v79, v125, v121, s78
    v_perm_b32 v80, v102, v98, s77
    v_perm_b32 v81, v110, v106, s77
    v_perm_b32 v82, v118, v114, s77
    v_perm_b32 v83, v126, v122, s77
    v_perm_b32 v84, v102, v98, s78
    v_perm_b32 v85, v110, v106, s78
    v_perm_b32 v86, v118, v114, s78
    v_perm_b32 v87, v126, v122, s78
    v_perm_b32 v88, v103, v99, s77
    v_perm_b32 v89, v111, v107, s77
    v_perm_b32 v90, v119, v115, s77
    v_perm_b32 v91, v127, v123, s77
    v_perm_b32 v92, v103, v99, s78
    v_perm_b32 v93, v111, v107, s78
    v_perm_b32 v94, v119, v115, s78
    v_perm_b32 v95, v127, v123, s78
    s_waitcnt vmcnt(11)
    v_xor_b32 v15, s72, v50
    v_bitop3_b32 v15, v15, v51, s73 bitop3:0xf6
    v_bitop3_b32 v15, v15, v52, s74 bitop3:0xf6
    v_bitop3_b32 v15, v15, v53, s75 bitop3:0xf6
    v_and_b32 v15, s76, v15
    v_cmp_ne_u32 vcc, 0, v15
    s_cbranch_vccz L_ok29
    s_mov_b64 s[94:95], exec
    s_mov_b32 s88, 0
L_spin30:
    s_and_b64 exec, exec, vcc
    s_sleep 16
    buffer_load_dwordx4 v[50:53], v9, s[64:67], s27 offen sc1
    s_waitcnt vmcnt(0)
    v_xor_b32 v15, s72, v50
    v_bitop3_b32 v15, v15, v51, s73 bitop3:0xf6
    v_bitop3_b32 v15, v15, v52, s74 bitop3:0xf6
    v_bitop3_b32 v15, v15, v53, s75 bitop3:0xf6
    v_and_b32 v15, s76, v15
    v_cmp_ne_u32 vcc, 0, v15
    s_add_u32 s88, s88, 1
    s_cmp_ge_u32 s88, 20000
    s_cbranch_scc1 L_res31
    s_cbranch_vccnz L_spin30
L_res31:
    s_mov_b64 exec, s[94:95]
L_ok29:
    v_and_b32 v50, 0xffff0000, v50
    v_mov_b32 v54, v50
    v_mov_b32 v55, v54
    s_nop 1
    v_permlane32_swap_b32 v55, v54
    v_max_f32 v54, v55, v54
    v_mov_b32 v55, v54
    s_nop 1
    v_permlane16_swap_b32 v55, v54
    v_max_f32 v54, v55, v54
    s_nop 1
    v_max_f32_dpp v54, v54, v54 row_ror:8 row_mask:0xf bank_mask:0xf
    s_nop 1
    v_max_f32_dpp v54, v54, v54 row_ror:4 row_mask:0xf bank_mask:0xf
    s_nop 1
    v_max_f32_dpp v54, v54, v54 row_ror:2 row_mask:0xf bank_mask:0xf
    s_nop 1
    v_max_f32_dpp v54, v54, v54 row_ror:1 row_mask:0xf bank_mask:0xf
    v_sub_f32 v50, v50, v54
    v_mul_f32 v50, s80, v50
    v_exp_f32 v50, v50
    s_nop 0
    v_mul_f32 v54, v50, v51
    v_mov_b32 v55, v54
    s_nop 1
    v_permlane32_swap_b32 v55, v54
    v_add_f32 v54, v55, v54
    v_mov_b32 v55, v54
    s_nop 1
    v_permlane16_swap_b32 v55, v54
    v_add_f32 v54, v55, v54
    s_nop 1
    v_add_f32_dpp v54, v54, v54 row_ror:8 row_mask:0xf bank_mask:0xf
    s_nop 1
    v_add_f32_dpp v54, v54, v54 row_ror:4 row_mask:0xf bank_mask:0xf
    s_nop 1
    v_add_f32_dpp v54, v54, v54 row_ror:2 row_mask:0xf bank_mask:0xf
    s_nop 1
    v_add_f32_dpp v54, v54, v54 row_ror:1 row_mask:0xf bank_mask:0xf
    v_rcp_f32 v54, v54
    s_lshl_b32 s89, s3, 6
    v_lshrrev_b32 v15, 3, v14
    v_lshl_add_u32 v15, v15, 2, s89
    v_mul_f32 v50, v50, v54
    ds_bpermute_b32 v7, v15, v50
    ds_bpermute_b32 v39, v15, v50 offset:32
    s_waitcnt lgkmcnt(0)
    s_waitcnt vmcnt(8)
    v_xor_b32 v15, s72, v236
    v_bitop3_b32 v15, v15, v237, s73 bitop3:0xf6
    v_bitop3_b32 v15, v15, v238, s74 bitop3:0xf6
    v_bitop3_b32 v15, v15, v239, s75 bitop3:0xf6
    v_and_b32 v15, s76, v15
    v_cmp_ne_u32 vcc, 0, v15
    s_cbranch_vccz L_ok34
    s_mov_b64 s[94:95], exec
    s_mov_b32 s88, 0
L_spin35:
    s_and_b64 exec, exec, vcc
    s_sleep 16
    buffer_load_dwordx4 v[236:239], v9, s[64:67], s83 offen sc1
    s_waitcnt vmcnt(0)
    v_xor_b32 v15, s72, v236
    v_bitop3_b32 v15, v15, v237, s73 bitop3:0xf6
    v_bitop3_b32 v15, v15, v238, s74 bitop3:0xf6
    v_bitop3_b32 v15, v15, v239, s75 bitop3:0xf6
    v_and_b32 v15, s76, v15
    v_cmp_ne_u32 vcc, 0, v15
    s_add_u32 s88, s88, 1
    s_cmp_ge_u32 s88, 20000
    s_cbranch_scc1 L_res36
    s_cbranch_vccnz L_spin35
L_res36:
    s_mov_b64 exec, s[94:95]
L_ok34:
    v_and_b32 v236, 0xffff0000, v236
    v_mov_b32 v54, v236
    v_mov_b32 v55, v54
    s_nop 1
    v_permlane32_swap_b32 v55, v54
    v_max_f32 v54, v55, v54
    v_mov_b32 v55, v54
    s_nop 1
    v_permlane16_swap_b32 v55, v54
    v_max_f32 v54, v55, v54
    s_nop 1
    v_max_f32_dpp v54, v54, v54 row_ror:8 row_mask:0xf bank_mask:0xf
    s_nop 1
    v_max_f32_dpp v54, v54, v54 row_ror:4 row_mask:0xf bank_mask:0xf
    s_nop 1
    v_max_f32_dpp v54, v54, v54 row_ror:2 row_mask:0xf bank_mask:0xf
    s_nop 1
    v_max_f32_dpp v54, v54, v54 row_ror:1 row_mask:0xf bank_mask:0xf
    v_sub_f32 v236, v236, v54
    v_mul_f32 v236, s80, v236
    v_exp_f32 v236, v236
    s_nop 0
    v_mul_f32 v54, v236, v237
    v_mov_b32 v55, v54
    s_nop 1
    v_permlane32_swap_b32 v55, v54
    v_add_f32 v54, v55, v54
    v_mov_b32 v55, v54
    s_nop 1
    v_permlane16_swap_b32 v55, v54
    v_add_f32 v54, v55, v54
    s_nop 1
    v_add_f32_dpp v54, v54, v54 row_ror:8 row_mask:0xf bank_mask:0xf
    s_nop 1
    v_add_f32_dpp v54, v54, v54 row_ror:4 row_mask:0xf bank_mask:0xf
    s_nop 1
    v_add_f32_dpp v54, v54, v54 row_ror:2 row_mask:0xf bank_mask:0xf
    s_nop 1
    v_add_f32_dpp v54, v54, v54 row_ror:1 row_mask:0xf bank_mask:0xf
    v_rcp_f32 v54, v54
    s_lshl_b32 s89, s3, 6
    v_lshrrev_b32 v15, 3, v14
    v_lshl_add_u32 v15, v15, 2, s89
    v_mul_f32 v236, v236, v54
    ds_bpermute_b32 v40, v15, v236
    ds_bpermute_b32 v41, v15, v236 offset:32
    s_waitcnt lgkmcnt(0)
    v_xor_b32 v15, s72, v24
    v_bitop3_b32 v15, v15, v25, s73 bitop3:0xf6
    v_bitop3_b32 v15, v15, v26, s74 bitop3:0xf6
    v_bitop3_b32 v15, v15, v27, s75 bitop3:0xf6
    v_and_b32 v15, s76, v15
    v_cmp_ne_u32 vcc, 0, v15
    s_cbranch_vccz L_ok39
    s_mov_b64 s[94:95], exec
    s_mov_b32 s88, 0
L_spin40:
    s_and_b64 exec, exec, vcc
    s_sleep 8
    buffer_load_dwordx4 v[24:27], v20, s[64:67], s28 offen sc1
    s_waitcnt vmcnt(0)
    v_xor_b32 v15, s72, v24
    v_bitop3_b32 v15, v15, v25, s73 bitop3:0xf6
    v_bitop3_b32 v15, v15, v26, s74 bitop3:0xf6
    v_bitop3_b32 v15, v15, v27, s75 bitop3:0xf6
    v_and_b32 v15, s76, v15
    v_cmp_ne_u32 vcc, 0, v15
    s_add_u32 s88, s88, 1
    s_cmp_ge_u32 s88, 20000
    s_cbranch_scc1 L_res41
    s_cbranch_vccnz L_spin40
L_res41:
    s_mov_b64 exec, s[94:95]
L_ok39:
    v_xor_b32 v15, v46, v16
    v_bitop3_b32 v15, v15, v17, v47 bitop3:0xf6
    v_bitop3_b32 v15, v15, v18, v48 bitop3:0xf6
    v_bitop3_b32 v15, v15, v19, v49 bitop3:0xf6
    v_and_b32 v15, s19, v15
    v_cmp_ne_u32 vcc, 0, v15
    s_nop 0
    s_wqm_b64 vcc, vcc
    s_lshr_b64 s[90:91], vcc, 4
    s_or_b64 vcc, vcc, s[90:91]
    s_and_b64 vcc, vcc, s[14:15]
    s_lshl_b64 s[90:91], vcc, 4
    s_or_b64 vcc, vcc, s[90:91]
    s_cbranch_vccz L_ok44
    s_mov_b64 s[94:95], exec
    s_mov_b32 s88, 0
L_spin45:
    s_and_b64 exec, exec, vcc
    s_sleep 8
    buffer_load_dwordx4 v[16:19], v9, s[64:67], s98 offen sc1
    s_waitcnt vmcnt(0)
    v_xor_b32 v15, v46, v16
    v_bitop3_b32 v15, v15, v17, v47 bitop3:0xf6
    v_bitop3_b32 v15, v15, v18, v48 bitop3:0xf6
    v_bitop3_b32 v15, v15, v19, v49 bitop3:0xf6
    v_and_b32 v15, s19, v15
    v_cmp_ne_u32 vcc, 0, v15
    s_nop 0
    s_wqm_b64 vcc, vcc
    s_lshr_b64 s[90:91], vcc, 4
    s_or_b64 vcc, vcc, s[90:91]
    s_and_b64 vcc, vcc, s[14:15]
    s_lshl_b64 s[90:91], vcc, 4
    s_or_b64 vcc, vcc, s[90:91]
    s_add_u32 s88, s88, 1
    s_cmp_ge_u32 s88, 20000
    s_cbranch_scc1 L_res46
    s_cbranch_vccnz L_spin45
L_res46:
    s_mov_b64 exec, s[94:95]
L_ok44:
    v_and_b32 v24, 0xffff0000, v24
    v_mov_b32 v54, v24
    v_mov_b32 v55, v54
    s_nop 1
    v_permlane32_swap_b32 v55, v54
    v_max_f32 v54, v55, v54
    v_mov_b32 v55, v54
    s_nop 1
    v_permlane16_swap_b32 v55, v54
    v_max_f32 v54, v55, v54
    s_nop 1
    v_max_f32_dpp v54, v54, v54 row_ror:8 row_mask:0xf bank_mask:0xf
    v_sub_f32 v24, v24, v54
    v_mul_f32 v24, s80, v24
    v_exp_f32 v24, v24
    s_nop 0
    v_mul_f32 v54, v24, v25
    v_mov_b32 v55, v54
    s_nop 1
    v_permlane32_swap_b32 v55, v54
    v_add_f32 v54, v55, v54
    v_mov_b32 v55, v54
    s_nop 1
    v_permlane16_swap_b32 v55, v54
    v_add_f32 v54, v55, v54
    s_nop 1
    v_add_f32_dpp v54, v54, v54 row_ror:8 row_mask:0xf bank_mask:0xf
    v_rcp_f32 v54, v54
    s_nop 0
    v_mul_f32 v24, v24, v54
    v_lshlrev_b32 v28, 16, v16
    v_and_b32 v29, 0xffff0000, v16
    v_lshlrev_b32 v30, 16, v17
    v_and_b32 v31, 0xffff0000, v17
    v_lshlrev_b32 v32, 16, v18
    v_and_b32 v33, 0xffff0000, v18
    v_lshlrev_b32 v34, 16, v19
    v_and_b32 v35, 0xffff0000, v19
    v_mul_f32 v28, v24, v28
    v_mul_f32 v29, v24, v29
    v_mul_f32 v30, v24, v30
    v_mul_f32 v31, v24, v31
    v_mul_f32 v32, v24, v32
    v_mul_f32 v33, v24, v33
    v_mul_f32 v34, v24, v34
    v_mul_f32 v35, v24, v35
    v_permlane32_swap_b32 v28, v32
    v_permlane32_swap_b32 v29, v33
    v_permlane32_swap_b32 v30, v34
    v_permlane32_swap_b32 v31, v35
    v_add_f32 v28, v28, v32
    v_add_f32 v29, v29, v33
    v_add_f32 v30, v30, v34
    v_add_f32 v31, v31, v35
    v_permlane16_swap_b32 v28, v29
    s_nop 0
    v_permlane16_swap_b32 v30, v31
    v_add_f32 v28, v28, v29
    v_add_f32 v30, v30, v31
    s_nop 0
    v_add_f32_dpp v28, v28, v28 row_ror:8 row_mask:0xf bank_mask:0xf
    v_add_f32_dpp v30, v30, v30 row_ror:8 row_mask:0xf bank_mask:0xf
    ds_write_b32 v36, v28 offset:0
    ds_write_b32 v36, v30 offset:256
    s_lshl_b32 s89, s3, 2
    v_add_u32 v29, s89, v37
    s_waitcnt lgkmcnt(0)
    ds_read_b32 v28, v29
    s_waitcnt lgkmcnt(0)
    v_mov_b32_dpp v29, v28 quad_perm:[1,0,3,2] row_mask:0xf bank_mask:0xf
    v_cvt_pk_bf16_f32 v28, v28, v29
    s_nop 1
    v_mov_b32_dpp v24, v28 row_newbcast:0 row_mask:0xf bank_mask:0x3
    v_mov_b32_dpp v25, v28 row_newbcast:2 row_mask:0xf bank_mask:0x3
    v_mov_b32_dpp v26, v28 row_newbcast:4 row_mask:0xf bank_mask:0x3
    v_mov_b32_dpp v27, v28 row_newbcast:6 row_mask:0xf bank_mask:0x3
    v_mov_b32_dpp v24, v28 row_newbcast:8 row_mask:0xf bank_mask:0xc
    v_mov_b32_dpp v25, v28 row_newbcast:10 row_mask:0xf bank_mask:0xc
    v_mov_b32_dpp v26, v28 row_newbcast:12 row_mask:0xf bank_mask:0xc
    v_mov_b32_dpp v27, v28 row_newbcast:14 row_mask:0xf bank_mask:0xc
    v_xor_b32 v15, s72, v232
    v_bitop3_b32 v15, v15, v233, s73 bitop3:0xf6
    v_bitop3_b32 v15, v15, v234, s74 bitop3:0xf6
    v_bitop3_b32 v15, v15, v235, s75 bitop3:0xf6
    v_and_b32 v15, s76, v15
    v_cmp_ne_u32 vcc, 0, v15
    s_cbranch_vccz L_ok49
    s_mov_b64 s[94:95], exec
    s_mov_b32 s88, 0
L_spin50:
    s_and_b64 exec, exec, vcc
    s_sleep 8
    buffer_load_dwordx4 v[232:235], v20, s[64:67], s84 offen sc1
    s_waitcnt vmcnt(0)
    v_xor_b32 v15, s72, v232
    v_bitop3_b32 v15, v15, v233, s73 bitop3:0xf6
    v_bitop3_b32 v15, v15, v234, s74 bitop3:0xf6
    v_bitop3_b32 v15, v15, v235, s75 bitop3:0xf6
    v_and_b32 v15, s76, v15
    v_cmp_ne_u32 vcc, 0, v15
    s_add_u32 s88, s88, 1
    s_cmp_ge_u32 s88, 20000
    s_cbranch_scc1 L_res51
    s_cbranch_vccnz L_spin50
L_res51:
    s_mov_b64 exec, s[94:95]
L_ok49:
    v_xor_b32 v15, v46, v224
    v_bitop3_b32 v15, v15, v225, v47 bitop3:0xf6
    v_bitop3_b32 v15, v15, v226, v48 bitop3:0xf6
    v_bitop3_b32 v15, v15, v227, v49 bitop3:0xf6
    v_and_b32 v15, s19, v15
    v_cmp_ne_u32 vcc, 0, v15
    s_nop 0
    s_wqm_b64 vcc, vcc
    s_lshr_b64 s[90:91], vcc, 4
    s_or_b64 vcc, vcc, s[90:91]
    s_and_b64 vcc, vcc, s[14:15]
    s_lshl_b64 s[90:91], vcc, 4
    s_or_b64 vcc, vcc, s[90:91]
    s_cbranch_vccz L_ok54
    s_mov_b64 s[94:95], exec
    s_mov_b32 s88, 0
L_spin55:
    s_and_b64 exec, exec, vcc
    s_sleep 8
    buffer_load_dwordx4 v[224:227], v9, s[64:67], s99 offen sc1
    s_waitcnt vmcnt(0)
    v_xor_b32 v15, v46, v224
    v_bitop3_b32 v15, v15, v225, v47 bitop3:0xf6
    v_bitop3_b32 v15, v15, v226, v48 bitop3:0xf6
    v_bitop3_b32 v15, v15, v227, v49 bitop3:0xf6
    v_and_b32 v15, s19, v15
    v_cmp_ne_u32 vcc, 0, v15
    s_nop 0
    s_wqm_b64 vcc, vcc
    s_lshr_b64 s[90:91], vcc, 4
    s_or_b64 vcc, vcc, s[90:91]
    s_and_b64 vcc, vcc, s[14:15]
    s_lshl_b64 s[90:91], vcc, 4
    s_or_b64 vcc, vcc, s[90:91]
    s_add_u32 s88, s88, 1
    s_cmp_ge_u32 s88, 20000
    s_cbranch_scc1 L_res56
    s_cbranch_vccnz L_spin55
L_res56:
    s_mov_b64 exec, s[94:95]
L_ok54:
    v_and_b32 v232, 0xffff0000, v232
    v_mov_b32 v54, v232
    v_mov_b32 v55, v54
    s_nop 1
    v_permlane32_swap_b32 v55, v54
    v_max_f32 v54, v55, v54
    v_mov_b32 v55, v54
    s_nop 1
    v_permlane16_swap_b32 v55, v54
    v_max_f32 v54, v55, v54
    s_nop 1
    v_max_f32_dpp v54, v54, v54 row_ror:8 row_mask:0xf bank_mask:0xf
    v_sub_f32 v232, v232, v54
    v_mul_f32 v232, s80, v232
    v_exp_f32 v232, v232
    s_nop 0
    v_mul_f32 v54, v232, v233
    v_mov_b32 v55, v54
    s_nop 1
    v_permlane32_swap_b32 v55, v54
    v_add_f32 v54, v55, v54
    v_mov_b32 v55, v54
    s_nop 1
    v_permlane16_swap_b32 v55, v54
    v_add_f32 v54, v55, v54
    s_nop 1
    v_add_f32_dpp v54, v54, v54 row_ror:8 row_mask:0xf bank_mask:0xf
    v_rcp_f32 v54, v54
    s_nop 0
    v_mul_f32 v232, v232, v54
    v_lshlrev_b32 v28, 16, v224
    v_and_b32 v29, 0xffff0000, v224
    v_lshlrev_b32 v30, 16, v225
    v_and_b32 v31, 0xffff0000, v225
    v_lshlrev_b32 v32, 16, v226
    v_and_b32 v33, 0xffff0000, v226
    v_lshlrev_b32 v34, 16, v227
    v_and_b32 v35, 0xffff0000, v227
    v_mul_f32 v28, v232, v28
    v_mul_f32 v29, v232, v29
    v_mul_f32 v30, v232, v30
    v_mul_f32 v31, v232, v31
    v_mul_f32 v32, v232, v32
    v_mul_f32 v33, v232, v33
    v_mul_f32 v34, v232, v34
    v_mul_f32 v35, v232, v35
    v_permlane32_swap_b32 v28, v32
    v_permlane32_swap_b32 v29, v33
    v_permlane32_swap_b32 v30, v34
    v_permlane32_swap_b32 v31, v35
    v_add_f32 v28, v28, v32
    v_add_f32 v29, v29, v33
    v_add_f32 v30, v30, v34
    v_add_f32 v31, v31, v35
    v_permlane16_swap_b32 v28, v29
    s_nop 0
    v_permlane16_swap_b32 v30, v31
    v_add_f32 v28, v28, v29
    v_add_f32 v30, v30, v31
    s_nop 0
    v_add_f32_dpp v28, v28, v28 row_ror:8 row_mask:0xf bank_mask:0xf
    v_add_f32_dpp v30, v30, v30 row_ror:8 row_mask:0xf bank_mask:0xf
    ds_write_b32 v36, v28 offset:0
    ds_write_b32 v36, v30 offset:256
    s_lshl_b32 s89, s3, 2
    v_add_u32 v29, s89, v37
    s_waitcnt lgkmcnt(0)
    ds_read_b32 v28, v29
    s_waitcnt lgkmcnt(0)
    v_mov_b32_dpp v29, v28 quad_perm:[1,0,3,2] row_mask:0xf bank_mask:0xf
    v_cvt_pk_bf16_f32 v28, v28, v29
    s_nop 1
    v_mov_b32_dpp v42, v28 row_newbcast:0 row_mask:0xf bank_mask:0x3
    v_mov_b32_dpp v43, v28 row_newbcast:2 row_mask:0xf bank_mask:0x3
    v_mov_b32_dpp v44, v28 row_newbcast:4 row_mask:0xf bank_mask:0x3
    v_mov_b32_dpp v45, v28 row_newbcast:6 row_mask:0xf bank_mask:0x3
    v_mov_b32_dpp v42, v28 row_newbcast:8 row_mask:0xf bank_mask:0xc
    v_mov_b32_dpp v43, v28 row_newbcast:10 row_mask:0xf bank_mask:0xc
    v_mov_b32_dpp v44, v28 row_newbcast:12 row_mask:0xf bank_mask:0xc
    v_mov_b32_dpp v45, v28 row_newbcast:14 row_mask:0xf bank_mask:0xc
    v_mfma_f32_16x16x32_bf16 v[96:99], v[24:27], v[64:67], 0
    v_mfma_f32_16x16x32_bf16 v[112:115], v[24:27], v[80:83], 0
    v_mfma_f32_16x16x32_bf16 v[100:103], v[24:27], v[68:71], 0
    v_mfma_f32_16x16x32_bf16 v[116:119], v[24:27], v[84:87], 0
    v_mfma_f32_16x16x32_bf16 v[104:107], v[24:27], v[72:75], 0
    v_mfma_f32_16x16x32_bf16 v[120:123], v[24:27], v[88:91], 0
    v_mfma_f32_16x16x32_bf16 v[108:111], v[24:27], v[76:79], 0
    v_mfma_f32_16x16x32_bf16 v[124:127], v[24:27], v[92:95], 0
    s_nop 1
    v_permlane32_swap_b32 v96, v112
    s_nop 0
    v_permlane32_swap_b32 v100, v116
    s_nop 0
    v_permlane32_swap_b32 v104, v120
    s_nop 0
    v_permlane32_swap_b32 v108, v124
    v_add_f32_dpp v96, v112, v96 row_ror:8 row_mask:0xf bank_mask:0xf
    v_add_f32_dpp v100, v116, v100 row_ror:8 row_mask:0xf bank_mask:0xf
    v_add_f32_dpp v104, v120, v104 row_ror:8 row_mask:0xf bank_mask:0xf
    v_add_f32_dpp v108, v124, v108 row_ror:8 row_mask:0xf bank_mask:0xf
    v_bfi_b32 v50, s76, v0, v96
    v_bfi_b32 v51, s76, v4, v100
    v_bfi_b32 v52, s76, v62, v104
    v_bfi_b32 v53, s76, v63, v108
    v_perm_b32 v224, v132, v128, s77
    v_perm_b32 v225, v140, v136, s77
    v_perm_b32 v226, v148, v144, s77
    v_perm_b32 v227, v156, v152, s77
    v_perm_b32 v228, v132, v128, s78
    v_perm_b32 v229, v140, v136, s78
    v_perm_b32 v230, v148, v144, s78
    v_perm_b32 v231, v156, v152, s78
    v_perm_b32 v232, v133, v129, s77
    v_perm_b32 v233, v141, v137, s77
    v_perm_b32 v234, v149, v145, s77
    v_perm_b32 v235, v157, v153, s77
    v_perm_b32 v236, v133, v129, s78
    v_perm_b32 v237, v141, v137, s78
    v_perm_b32 v238, v149, v145, s78
    v_perm_b32 v239, v157, v153, s78
    v_perm_b32 v240, v134, v130, s77
    v_perm_b32 v241, v142, v138, s77
    v_perm_b32 v242, v150, v146, s77
    v_perm_b32 v243, v158, v154, s77
    v_perm_b32 v244, v134, v130, s78
    v_perm_b32 v245, v142, v138, s78
    v_perm_b32 v246, v150, v146, s78
    v_perm_b32 v247, v158, v154, s78
    v_perm_b32 v248, v135, v131, s77
    v_perm_b32 v249, v143, v139, s77
    v_perm_b32 v250, v151, v147, s77
    v_perm_b32 v251, v159, v155, s77
    v_perm_b32 v252, v135, v131, s78
    v_perm_b32 v253, v143, v139, s78
    v_perm_b32 v254, v151, v147, s78
    v_perm_b32 v255, v159, v155, s78
    buffer_load_dwordx4 v[16:19], v9, s[64:67], s93 offen offset:0 sc1
    buffer_load_dwordx4 v[20:23], v9, s[64:67], s93 offen offset:1024 sc1
    buffer_load_dwordx4 v[54:57], v9, s[64:67], s23 offen offset:0 sc1
    buffer_load_dwordx4 v[58:61], v9, s[64:67], s23 offen offset:1024 sc1
    v_perm_b32 v64, v164, v160, s77
    v_perm_b32 v65, v172, v168, s77
    v_perm_b32 v66, v180, v176, s77
    v_perm_b32 v67, v188, v184, s77
    v_perm_b32 v68, v164, v160, s78
    v_perm_b32 v69, v172, v168, s78
    v_perm_b32 v70, v180, v176, s78
    v_perm_b32 v71, v188, v184, s78
    v_perm_b32 v72, v165, v161, s77
    v_perm_b32 v73, v173, v169, s77
    v_perm_b32 v74, v181, v177, s77
    v_perm_b32 v75, v189, v185, s77
    v_perm_b32 v76, v165, v161, s78
    v_perm_b32 v77, v173, v169, s78
    v_perm_b32 v78, v181, v177, s78
    v_perm_b32 v79, v189, v185, s78
    v_perm_b32 v80, v166, v162, s77
    v_perm_b32 v81, v174, v170, s77
    v_perm_b32 v82, v182, v178, s77
    v_perm_b32 v83, v190, v186, s77
    v_perm_b32 v84, v166, v162, s78
    v_perm_b32 v85, v174, v170, s78
    v_perm_b32 v86, v182, v178, s78
    v_perm_b32 v87, v190, v186, s78
    v_perm_b32 v88, v167, v163, s77
    v_perm_b32 v89, v175, v171, s77
    v_perm_b32 v90, v183, v179, s77
    v_perm_b32 v91, v191, v187, s77
    v_perm_b32 v92, v167, v163, s78
    v_perm_b32 v93, v175, v171, s78
    v_perm_b32 v94, v183, v179, s78
    v_perm_b32 v95, v191, v187, s78
    v_mfma_f32_16x16x32_bf16 v[160:163], v[42:45], v[64:67], 0
    v_mfma_f32_16x16x32_bf16 v[176:179], v[42:45], v[80:83], 0
    v_mfma_f32_16x16x32_bf16 v[164:167], v[42:45], v[68:71], 0
    v_mfma_f32_16x16x32_bf16 v[180:183], v[42:45], v[84:87], 0
    v_mfma_f32_16x16x32_bf16 v[168:171], v[42:45], v[72:75], 0
    v_mfma_f32_16x16x32_bf16 v[184:187], v[42:45], v[88:91], 0
    v_mfma_f32_16x16x32_bf16 v[172:175], v[42:45], v[76:79], 0
    v_mfma_f32_16x16x32_bf16 v[188:191], v[42:45], v[92:95], 0
    s_nop 1
    v_permlane32_swap_b32 v160, v176
    s_nop 0
    v_permlane32_swap_b32 v164, v180
    s_nop 0
    v_permlane32_swap_b32 v168, v184
    s_nop 0
    v_permlane32_swap_b32 v172, v188
    v_add_f32_dpp v160, v176, v160 row_ror:8 row_mask:0xf bank_mask:0xf
    v_add_f32_dpp v164, v180, v164 row_ror:8 row_mask:0xf bank_mask:0xf
    v_add_f32_dpp v168, v184, v168 row_ror:8 row_mask:0xf bank_mask:0xf
    v_add_f32_dpp v172, v188, v172 row_ror:8 row_mask:0xf bank_mask:0xf
    v_bfi_b32 v176, s76, v0, v160
    v_bfi_b32 v177, s76, v4, v164
    v_bfi_b32 v178, s76, v62, v168
    v_bfi_b32 v179, s76, v63, v172
    s_add_u32 s98, s101, 0x40000
    s_add_u32 s99, s22, 0x40000
    s_waitcnt vmcnt(4)
    v_perm_b32 v96, v196, v192, s77
    v_perm_b32 v97, v204, v200, s77
    v_perm_b32 v98, v212, v208, s77
    v_perm_b32 v99, v220, v216, s77
    v_perm_b32 v100, v196, v192, s78
    v_perm_b32 v101, v204, v200, s78
    v_perm_b32 v102, v212, v208, s78
    v_perm_b32 v103, v220, v216, s78
    v_perm_b32 v104, v197, v193, s77
    v_perm_b32 v105, v205, v201, s77
    v_perm_b32 v106, v213, v209, s77
    v_perm_b32 v107, v221, v217, s77
    v_perm_b32 v108, v197, v193, s78
    v_perm_b32 v109, v205, v201, s78
    v_perm_b32 v110, v213, v209, s78
    v_perm_b32 v111, v221, v217, s78
    v_perm_b32 v112, v198, v194, s77
    v_perm_b32 v113, v206, v202, s77
    v_perm_b32 v114, v214, v210, s77
    v_perm_b32 v115, v222, v218, s77
    v_perm_b32 v116, v198, v194, s78
    v_perm_b32 v117, v206, v202, s78
    v_perm_b32 v118, v214, v210, s78
    v_perm_b32 v119, v222, v218, s78
    v_perm_b32 v120, v199, v195, s77
    v_perm_b32 v121, v207, v203, s77
    v_perm_b32 v122, v215, v211, s77
    v_perm_b32 v123, v223, v219, s77
    v_perm_b32 v124, v199, v195, s78
    v_perm_b32 v125, v207, v203, s78
    v_perm_b32 v126, v215, v211, s78
    v_perm_b32 v127, v223, v219, s78
    s_waitcnt vmcnt(0)
    v_xor_b32 v15, v46, v16
    v_bitop3_b32 v15, v15, v17, v47 bitop3:0xf6
    v_bitop3_b32 v15, v15, v18, v48 bitop3:0xf6
    v_bitop3_b32 v15, v15, v19, v49 bitop3:0xf6
    v_bitop3_b32 v15, v15, v20, v46 bitop3:0xf6
    v_bitop3_b32 v15, v15, v21, v47 bitop3:0xf6
    v_bitop3_b32 v15, v15, v22, v48 bitop3:0xf6
    v_bitop3_b32 v15, v15, v23, v49 bitop3:0xf6
    v_bitop3_b32 v15, v15, v54, v46 bitop3:0xf6
    v_bitop3_b32 v15, v15, v55, v47 bitop3:0xf6
    v_bitop3_b32 v15, v15, v56, v48 bitop3:0xf6
    v_bitop3_b32 v15, v15, v57, v49 bitop3:0xf6
    v_bitop3_b32 v15, v15, v58, v46 bitop3:0xf6
    v_bitop3_b32 v15, v15, v59, v47 bitop3:0xf6
    v_bitop3_b32 v15, v15, v60, v48 bitop3:0xf6
    v_bitop3_b32 v15, v15, v61, v49 bitop3:0xf6
    v_and_b32 v15, s19, v15
    v_cmp_ne_u32 vcc, 0, v15
    s_nop 0
    s_wqm_b64 vcc, vcc
    s_lshr_b64 s[90:91], vcc, 4
    s_or_b64 vcc, vcc, s[90:91]
    s_and_b64 vcc, vcc, s[14:15]
    s_lshl_b64 s[90:91], vcc, 4
    s_or_b64 vcc, vcc, s[90:91]
    s_cbranch_vccz L_ok59
    s_mov_b64 s[94:95], exec
    s_mov_b32 s88, 0
L_spin60:
    s_and_b64 exec, exec, vcc
    s_bcnt1_i32_b64 s29, vcc
    s_cmp_le_u32 s29, 16
    s_cbranch_scc1 L_fast62
    s_sleep 8
L_nb64:
    buffer_load_dwordx4 v[16:19], v9, s[64:67], s93 offen offset:0 sc1
    buffer_load_dwordx4 v[20:23], v9, s[64:67], s93 offen offset:1024 sc1
    buffer_load_dwordx4 v[54:57], v9, s[64:67], s23 offen offset:0 sc1
    buffer_load_dwordx4 v[58:61], v9, s[64:67], s23 offen offset:1024 sc1
    s_waitcnt vmcnt(0)
    v_xor_b32 v15, v46, v16
    v_bitop3_b32 v15, v15, v17, v47 bitop3:0xf6
    v_bitop3_b32 v15, v15, v18, v48 bitop3:0xf6
    v_bitop3_b32 v15, v15, v19, v49 bitop3:0xf6
    v_bitop3_b32 v15, v15, v20, v46 bitop3:0xf6
    v_bitop3_b32 v15, v15, v21, v47 bitop3:0xf6
    v_bitop3_b32 v15, v15, v22, v48 bitop3:0xf6
    v_bitop3_b32 v15, v15, v23, v49 bitop3:0xf6
    v_bitop3_b32 v15, v15, v54, v46 bitop3:0xf6
    v_bitop3_b32 v15, v15, v55, v47 bitop3:0xf6
    v_bitop3_b32 v15, v15, v56, v48 bitop3:0xf6
    v_bitop3_b32 v15, v15, v57, v49 bitop3:0xf6
    v_bitop3_b32 v15, v15, v58, v46 bitop3:0xf6
    v_bitop3_b32 v15, v15, v59, v47 bitop3:0xf6
    v_bitop3_b32 v15, v15, v60, v48 bitop3:0xf6
    v_bitop3_b32 v15, v15, v61, v49 bitop3:0xf6
    v_and_b32 v15, s19, v15
    v_cmp_ne_u32 vcc, 0, v15
    s_nop 0
    s_wqm_b64 vcc, vcc
    s_lshr_b64 s[90:91], vcc, 4
    s_or_b64 vcc, vcc, s[90:91]
    s_and_b64 vcc, vcc, s[14:15]
    s_lshl_b64 s[90:91], vcc, 4
    s_or_b64 vcc, vcc, s[90:91]
    s_add_u32 s88, s88, 1
    s_cmp_ge_u32 s88, 20000
    s_cbranch_scc1 L_res61
    s_cbranch_vccnz L_spin60
    s_branch L_res61
L_fast62:
    buffer_load_dwordx4 v[16:19], v9, s[64:67], s93 offen offset:0 sc1
    buffer_load_dwordx4 v[20:23], v9, s[64:67], s93 offen offset:1024 sc1
    buffer_load_dwordx4 v[54:57], v9, s[64:67], s23 offen offset:0 sc1
    buffer_load_dwordx4 v[58:61], v9, s[64:67], s23 offen offset:1024 sc1
    s_sleep 3
    buffer_load_dwordx4 v[16:19], v9, s[64:67], s93 offen offset:0 sc1
    buffer_load_dwordx4 v[20:23], v9, s[64:67], s93 offen offset:1024 sc1
    buffer_load_dwordx4 v[54:57], v9, s[64:67], s23 offen offset:0 sc1
    buffer_load_dwordx4 v[58:61], v9, s[64:67], s23 offen offset:1024 sc1
    s_sleep 3
    buffer_load_dwordx4 v[16:19], v9, s[64:67], s93 offen offset:0 sc1
    buffer_load_dwordx4 v[20:23], v9, s[64:67], s93 offen offset:1024 sc1
    buffer_load_dwordx4 v[54:57], v9, s[64:67], s23 offen offset:0 sc1
    buffer_load_dwordx4 v[58:61], v9, s[64:67], s23 offen offset:1024 sc1
    s_sleep 3
L_floop63:
    buffer_load_dwordx4 v[16:19], v9, s[64:67], s93 offen offset:0 sc1
    buffer_load_dwordx4 v[20:23], v9, s[64:67], s93 offen offset:1024 sc1
    buffer_load_dwordx4 v[54:57], v9, s[64:67], s23 offen offset:0 sc1
    buffer_load_dwordx4 v[58:61], v9, s[64:67], s23 offen offset:1024 sc1
    s_waitcnt vmcnt(12)
    v_xor_b32 v15, v46, v16
    v_bitop3_b32 v15, v15, v17, v47 bitop3:0xf6
    v_bitop3_b32 v15, v15, v18, v48 bitop3:0xf6
    v_bitop3_b32 v15, v15, v19, v49 bitop3:0xf6
    v_bitop3_b32 v15, v15, v20, v46 bitop3:0xf6
    v_bitop3_b32 v15, v15, v21, v47 bitop3:0xf6
    v_bitop3_b32 v15, v15, v22, v48 bitop3:0xf6
    v_bitop3_b32 v15, v15, v23, v49 bitop3:0xf6
    v_bitop3_b32 v15, v15, v54, v46 bitop3:0xf6
    v_bitop3_b32 v15, v15, v55, v47 bitop3:0xf6
    v_bitop3_b32 v15, v15, v56, v48 bitop3:0xf6
    v_bitop3_b32 v15, v15, v57, v49 bitop3:0xf6
    v_bitop3_b32 v15, v15, v58, v46 bitop3:0xf6
    v_bitop3_b32 v15, v15, v59, v47 bitop3:0xf6
    v_bitop3_b32 v15, v15, v60, v48 bitop3:0xf6
    v_bitop3_b32 v15, v15, v61, v49 bitop3:0xf6
    v_and_b32 v15, s19, v15
    v_cmp_ne_u32 vcc, 0, v15
    s_nop 0
    s_wqm_b64 vcc, vcc
    s_lshr_b64 s[90:91], vcc, 4
    s_or_b64 vcc, vcc, s[90:91]
    s_and_b64 vcc, vcc, s[14:15]
    s_lshl_b64 s[90:91], vcc, 4
    s_or_b64 vcc, vcc, s[90:91]
    s_add_u32 s88, s88, 1
    s_cmp_ge_u32 s88, 80000
    s_cbranch_scc1 L_res61
    s_and_b64 exec, exec, vcc
    s_cbranch_vccnz L_floop63
L_res61:
    s_mov_b64 exec, s[94:95]
L_ok59:
    s_mov_b32 exec_lo, 0xff
    s_mov_b32 exec_hi, 0xff
    buffer_store_dwordx4 v[50:53], v38, s[64:67], s101 offen sc1
    buffer_store_dwordx4 v[176:179], v38, s[64:67], s22 offen sc1
    s_mov_b64 exec, -1
    v_lshlrev_b32 v28, 16, v16
    v_and_b32 v29, 0xffff0000, v16
    v_lshlrev_b32 v30, 16, v17
    v_and_b32 v31, 0xffff0000, v17
    v_lshlrev_b32 v32, 16, v18
    v_and_b32 v33, 0xffff0000, v18
    v_lshlrev_b32 v34, 16, v19
    v_and_b32 v35, 0xffff0000, v19
    v_mul_f32 v28, v7, v28
    v_mul_f32 v29, v7, v29
    v_mul_f32 v30, v7, v30
    v_mul_f32 v31, v7, v31
    v_mul_f32 v32, v7, v32
    v_mul_f32 v33, v7, v33
    v_mul_f32 v34, v7, v34
    v_mul_f32 v35, v7, v35
    v_lshlrev_b32 v5, 16, v20
    v_and_b32 v6, 0xffff0000, v20
    v_fmac_f32 v28, v39, v5
    v_fmac_f32 v29, v39, v6
    v_lshlrev_b32 v5, 16, v21
    v_and_b32 v6, 0xffff0000, v21
    v_fmac_f32 v30, v39, v5
    v_fmac_f32 v31, v39, v6
    v_lshlrev_b32 v5, 16, v22
    v_and_b32 v6, 0xffff0000, v22
    v_fmac_f32 v32, v39, v5
    v_fmac_f32 v33, v39, v6
    v_lshlrev_b32 v5, 16, v23
    v_and_b32 v6, 0xffff0000, v23
    v_fmac_f32 v34, v39, v5
    v_fmac_f32 v35, v39, v6
    v_permlane32_swap_b32 v28, v32
    v_permlane32_swap_b32 v29, v33
    v_permlane32_swap_b32 v30, v34
    v_permlane32_swap_b32 v31, v35
    v_add_f32 v28, v28, v32
    v_add_f32 v29, v29, v33
    v_add_f32 v30, v30, v34
    v_add_f32 v31, v31, v35
    v_permlane16_swap_b32 v28, v29
    s_nop 0
    v_permlane16_swap_b32 v30, v31
    v_add_f32 v28, v28, v29
    v_add_f32 v30, v30, v31
    s_nop 0
    v_add_f32_dpp v28, v28, v28 row_ror:8 row_mask:0xf bank_mask:0xf
    v_add_f32_dpp v30, v30, v30 row_ror:8 row_mask:0xf bank_mask:0xf
    ds_write_b32 v36, v28 offset:1024
    ds_write_b32 v36, v30 offset:1280
    v_lshlrev_b32 v28, 16, v54
    v_and_b32 v29, 0xffff0000, v54
    v_lshlrev_b32 v30, 16, v55
    v_and_b32 v31, 0xffff0000, v55
    v_lshlrev_b32 v32, 16, v56
    v_and_b32 v33, 0xffff0000, v56
    v_lshlrev_b32 v34, 16, v57
    v_and_b32 v35, 0xffff0000, v57
    v_mul_f32 v28, v40, v28
    v_mul_f32 v29, v40, v29
    v_mul_f32 v30, v40, v30
    v_mul_f32 v31, v40, v31
    v_mul_f32 v32, v40, v32
    v_mul_f32 v33, v40, v33
    v_mul_f32 v34, v40, v34
    v_mul_f32 v35, v40, v35
    v_lshlrev_b32 v5, 16, v58
    v_and_b32 v6, 0xffff0000, v58
    v_fmac_f32 v28, v41, v5
    v_fmac_f32 v29, v41, v6
    v_lshlrev_b32 v5, 16, v59
    v_and_b32 v6, 0xffff0000, v59
    v_fmac_f32 v30, v41, v5
    v_fmac_f32 v31, v41, v6
    v_lshlrev_b32 v5, 16, v60
    v_and_b32 v6, 0xffff0000, v60
    v_fmac_f32 v32, v41, v5
    v_fmac_f32 v33, v41, v6
    v_lshlrev_b32 v5, 16, v61
    v_and_b32 v6, 0xffff0000, v61
    v_fmac_f32 v34, v41, v5
    v_fmac_f32 v35, v41, v6
    v_permlane32_swap_b32 v28, v32
    v_permlane32_swap_b32 v29, v33
    v_permlane32_swap_b32 v30, v34
    v_permlane32_swap_b32 v31, v35
    v_add_f32 v28, v28, v32
    v_add_f32 v29, v29, v33
    v_add_f32 v30, v30, v34
    v_add_f32 v31, v31, v35
    v_permlane16_swap_b32 v28, v29
    s_nop 0
    v_permlane16_swap_b32 v30, v31
    v_add_f32 v28, v28, v29
    v_add_f32 v30, v30, v31
    s_nop 0
    v_add_f32_dpp v28, v28, v28 row_ror:8 row_mask:0xf bank_mask:0xf
    v_add_f32_dpp v30, v30, v30 row_ror:8 row_mask:0xf bank_mask:0xf
    ds_write_b32 v36, v28 offset:2048
    ds_write_b32 v36, v30 offset:2304
    s_waitcnt lgkmcnt(0)
    s_barrier
    ds_read_b128 v[28:31], v37 offset:1024
    ds_read_b128 v[32:35], v37 offset:2048
    s_waitcnt lgkmcnt(1)
    v_add_f32 v28, v28, v29
    v_add_f32 v30, v30, v31
    v_add_f32 v28, v28, v30
    s_nop 1
    v_mov_b32_dpp v29, v28 quad_perm:[1,0,3,2] row_mask:0xf bank_mask:0xf
    v_cvt_pk_bf16_f32 v28, v28, v29
    s_nop 1
    v_mov_b32_dpp v24, v28 row_newbcast:0 row_mask:0xf bank_mask:0x3
    v_mov_b32_dpp v25, v28 row_newbcast:2 row_mask:0xf bank_mask:0x3
    v_mov_b32_dpp v26, v28 row_newbcast:4 row_mask:0xf bank_mask:0x3
    v_mov_b32_dpp v27, v28 row_newbcast:6 row_mask:0xf bank_mask:0x3
    v_mov_b32_dpp v24, v28 row_newbcast:8 row_mask:0xf bank_mask:0xc
    v_mov_b32_dpp v25, v28 row_newbcast:10 row_mask:0xf bank_mask:0xc
    v_mov_b32_dpp v26, v28 row_newbcast:12 row_mask:0xf bank_mask:0xc
    v_mov_b32_dpp v27, v28 row_newbcast:14 row_mask:0xf bank_mask:0xc
    s_nop 1
    v_mfma_f32_16x16x32_bf16 v[128:131], v[24:27], v[224:227], 0
    v_mfma_f32_16x16x32_bf16 v[144:147], v[24:27], v[240:243], 0
    v_mfma_f32_16x16x32_bf16 v[132:135], v[24:27], v[228:231], 0
    v_mfma_f32_16x16x32_bf16 v[148:151], v[24:27], v[244:247], 0
    v_mfma_f32_16x16x32_bf16 v[136:139], v[24:27], v[232:235], 0
    v_mfma_f32_16x16x32_bf16 v[152:155], v[24:27], v[248:251], 0
    v_mfma_f32_16x16x32_bf16 v[140:143], v[24:27], v[236:239], 0
    v_mfma_f32_16x16x32_bf16 v[156:159], v[24:27], v[252:255], 0
    s_waitcnt lgkmcnt(0)
    v_add_f32 v32, v32, v33
    v_add_f32 v34, v34, v35
    v_add_f32 v32, v32, v34
    s_nop 1
    v_mov_b32_dpp v33, v32 quad_perm:[1,0,3,2] row_mask:0xf bank_mask:0xf
    v_cvt_pk_bf16_f32 v32, v32, v33
    s_nop 1
    v_mov_b32_dpp v42, v32 row_newbcast:0 row_mask:0xf bank_mask:0x3
    v_mov_b32_dpp v43, v32 row_newbcast:2 row_mask:0xf bank_mask:0x3
    v_mov_b32_dpp v44, v32 row_newbcast:4 row_mask:0xf bank_mask:0x3
    v_mov_b32_dpp v45, v32 row_newbcast:6 row_mask:0xf bank_mask:0x3
    v_mov_b32_dpp v42, v32 row_newbcast:8 row_mask:0xf bank_mask:0xc
    v_mov_b32_dpp v43, v32 row_newbcast:10 row_mask:0xf bank_mask:0xc
    v_mov_b32_dpp v44, v32 row_newbcast:12 row_mask:0xf bank_mask:0xc
    v_mov_b32_dpp v45, v32 row_newbcast:14 row_mask:0xf bank_mask:0xc
    s_nop 1
    v_mfma_f32_16x16x32_bf16 v[192:195], v[42:45], v[96:99], 0
    v_mfma_f32_16x16x32_bf16 v[208:211], v[42:45], v[112:115], 0
    v_mfma_f32_16x16x32_bf16 v[196:199], v[42:45], v[100:103], 0
    v_mfma_f32_16x16x32_bf16 v[212:215], v[42:45], v[116:119], 0
    v_mfma_f32_16x16x32_bf16 v[200:203], v[42:45], v[104:107], 0
    v_mfma_f32_16x16x32_bf16 v[216:219], v[42:45], v[120:123], 0
    v_mfma_f32_16x16x32_bf16 v[204:207], v[42:45], v[108:111], 0
    v_mfma_f32_16x16x32_bf16 v[220:223], v[42:45], v[124:127], 0
    v_permlane32_swap_b32 v128, v144
    v_permlane32_swap_b32 v132, v148
    v_permlane32_swap_b32 v136, v152
    v_permlane32_swap_b32 v140, v156
    v_add_f32_dpp v128, v144, v128 row_ror:8 row_mask:0xf bank_mask:0xf
    v_add_f32_dpp v132, v148, v132 row_ror:8 row_mask:0xf bank_mask:0xf
    v_add_f32_dpp v136, v152, v136 row_ror:8 row_mask:0xf bank_mask:0xf
    v_add_f32_dpp v140, v156, v140 row_ror:8 row_mask:0xf bank_mask:0xf
    v_bfi_b32 v28, s76, v0, v128
    v_bfi_b32 v29, s76, v4, v132
    v_bfi_b32 v30, s76, v62, v136
    v_bfi_b32 v31, s76, v63, v140
    s_mov_b32 exec_lo, 0xff
    s_mov_b32 exec_hi, 0xff
    buffer_store_dwordx4 v[28:31], v38, s[64:67], s98 offen sc1
    s_mov_b64 exec, -1
    v_permlane32_swap_b32 v192, v208
    v_permlane32_swap_b32 v196, v212
    v_permlane32_swap_b32 v200, v216
    v_permlane32_swap_b32 v204, v220
    v_add_f32_dpp v192, v208, v192 row_ror:8 row_mask:0xf bank_mask:0xf
    v_add_f32_dpp v196, v212, v196 row_ror:8 row_mask:0xf bank_mask:0xf
    v_add_f32_dpp v200, v216, v200 row_ror:8 row_mask:0xf bank_mask:0xf
    v_add_f32_dpp v204, v220, v204 row_ror:8 row_mask:0xf bank_mask:0xf
    v_bfi_b32 v32, s76, v0, v192
    v_bfi_b32 v33, s76, v4, v196
    v_bfi_b32 v34, s76, v62, v200
    v_bfi_b32 v35, s76, v63, v204
    s_mov_b32 exec_lo, 0xff
    s_mov_b32 exec_hi, 0xff
    buffer_store_dwordx4 v[32:35], v38, s[64:67], s99 offen sc1
    s_mov_b64 exec, -1
L_pub:
L_none:
L_red:
    s_cmp_ge_u32 s16, 64
    s_cbranch_scc1 L_fin
    s_lshr_b32 s89, s16, 5
    s_lshl_b32 s89, s89, 18
    s_and_b32 s90, s16, 31
    s_lshl_b32 s90, s90, 7
    s_add_u32 s89, s89, s90
    s_lshl_b32 s90, s3, 16
    s_add_u32 s89, s89, s90
    s_add_u32 s93, s89, 1572864
    s_add_u32 s98, s93, 0x8000
    v_lshrrev_b32 v24, 3, v14
    v_and_b32 v25, 7, v14
    v_lshlrev_b32 v24, 12, v24
    v_lshl_add_u32 v24, v25, 4, v24
    buffer_load_dwordx4 v[64:67], v24, s[64:67], s93 offen sc1
    buffer_load_dwordx4 v[68:71], v24, s[64:67], s98 offen sc1
    s_lshl_b32 s89, s3, 2
    s_add_u32 s89, s89, 156672
    v_lshl_add_u32 v26, v2, 3, v25
    v_lshl_add_u32 v26, v26, 4, s89
    v_add_u32 v42, 156672, v9
    v_lshrrev_b32 v43, 3, v14
    v_lshlrev_b32 v43, 1, v43
    v_lshl_add_u32 v43, v25, 4, v43
    s_lshr_b32 s89, s16, 1
    s_lshl_b32 s89, s89, 7
    s_and_b32 s90, s16, 1
    s_lshl_b32 s90, s90, 3
    s_add_u32 s92, s89, s90
    s_waitcnt vmcnt(0)
    v_xor_b32 v15, s72, v64
    v_bitop3_b32 v15, v15, v65, s73 bitop3:0xf6
    v_bitop3_b32 v15, v15, v66, s74 bitop3:0xf6
    v_bitop3_b32 v15, v15, v67, s75 bitop3:0xf6
    v_bitop3_b32 v15, v15, v68, s72 bitop3:0xf6
    v_bitop3_b32 v15, v15, v69, s73 bitop3:0xf6
    v_bitop3_b32 v15, v15, v70, s74 bitop3:0xf6
    v_bitop3_b32 v15, v15, v71, s75 bitop3:0xf6
    v_and_b32 v15, s76, v15
    v_cmp_ne_u32 vcc, 0, v15
    s_cbranch_vccz L_ok65
    s_mov_b64 s[94:95], exec
    s_mov_b32 s88, 0
L_spin66:
    s_and_b64 exec, exec, vcc
L_fast68:
    buffer_load_dwordx4 v[64:67], v24, s[64:67], s93 offen sc1
    buffer_load_dwordx4 v[68:71], v24, s[64:67], s98 offen sc1
    s_sleep 3
    buffer_load_dwordx4 v[64:67], v24, s[64:67], s93 offen sc1
    buffer_load_dwordx4 v[68:71], v24, s[64:67], s98 offen sc1
    s_sleep 3
    buffer_load_dwordx4 v[64:67], v24, s[64:67], s93 offen sc1
    buffer_load_dwordx4 v[68:71], v24, s[64:67], s98 offen sc1
    s_sleep 3
L_floop69:
    buffer_load_dwordx4 v[64:67], v24, s[64:67], s93 offen sc1
    buffer_load_dwordx4 v[68:71], v24, s[64:67], s98 offen sc1
    s_waitcnt vmcnt(6)
    v_xor_b32 v15, s72, v64
    v_bitop3_b32 v15, v15, v65, s73 bitop3:0xf6
    v_bitop3_b32 v15, v15, v66, s74 bitop3:0xf6
    v_bitop3_b32 v15, v15, v67, s75 bitop3:0xf6
    v_bitop3_b32 v15, v15, v68, s72 bitop3:0xf6
    v_bitop3_b32 v15, v15, v69, s73 bitop3:0xf6
    v_bitop3_b32 v15, v15, v70, s74 bitop3:0xf6
    v_bitop3_b32 v15, v15, v71, s75 bitop3:0xf6
    v_and_b32 v15, s76, v15
    v_cmp_ne_u32 vcc, 0, v15
    s_add_u32 s88, s88, 1
    s_cmp_ge_u32 s88, 80000
    s_cbranch_scc1 L_res67
    s_and_b64 exec, exec, vcc
    s_cbranch_vccnz L_floop69
L_res67:
    s_mov_b64 exec, s[94:95]
L_ok65:
    v_add_f32 v80, v64, v68
    v_add_f32 v81, v65, v69
    v_add_f32 v82, v66, v70
    v_add_f32 v83, v67, v71
    s_nop 0
    v_permlane32_swap_b32 v80, v82
    v_permlane32_swap_b32 v81, v83
    v_add_f32 v80, v80, v82
    v_add_f32 v81, v81, v83
    s_nop 1
    v_permlane16_swap_b32 v80, v81
    v_add_f32 v80, v80, v81
    s_nop 1
    v_add_f32_dpp v80, v80, v80 row_ror:8 row_mask:0xf bank_mask:0xf
    ds_write_b32 v26, v80
    s_waitcnt lgkmcnt(0)
    s_barrier
    s_cmp_lg_u32 s3, 0
    s_cbranch_scc1 L_fin
    s_mov_b32 exec_hi, 0
    ds_read_b128 v[80:83], v42
    s_waitcnt lgkmcnt(0)
    v_add_f32 v80, v80, v81
    v_add_f32 v82, v82, v83
    v_add_f32 v80, v80, v82
    v_cvt_pk_bf16_f32 v80, v80, v80
    buffer_store_short v80, v43, s[68:71], s92 offen
    s_cmp_lg_u32 s16, 32
    s_cbranch_scc1 L_fin
    s_mov_b64 exec, 1
    v_mov_b32 v81, s30
    v_mov_b32 v82, 0
    buffer_store_dword v81, v82, s[64:67], 0 offen offset:0 sc1
L_fin:
L_end:
    s_endpgm
.section .rodata,"a"
.p2align 6
.amdhsa_kernel concat_heads__sliding_block_cached__gqa_block_cached__decode_kernel
  .amdhsa_next_free_vgpr 384
  .amdhsa_next_free_sgpr 102
  .amdhsa_accum_offset 256
  .amdhsa_group_segment_fixed_size 0
  .amdhsa_kernarg_size 104
  .amdhsa_user_sgpr_count 2
  .amdhsa_user_sgpr_kernarg_segment_ptr 1
  .amdhsa_system_sgpr_workgroup_id_x 1
  .amdhsa_float_denorm_mode_32 3
.end_amdhsa_kernel
```
